```python
import torch

def _softmax(x, axis=-1):
    return torch.softmax(x, dim=axis)
def _gelu(x):
    return torch.nn.functional.gelu(x, approximate="tanh")
def _silu(x):
    return torch.nn.functional.silu(x)
def _sigmoid(x):
    return torch.sigmoid(x)
def _layernorm(x, axis=-1, eps=1e-5):
    m = x.mean(dim=axis, keepdim=True)
    v = x.var(dim=axis, keepdim=True, unbiased=False)
    return (x - m) / torch.sqrt(v + eps)
def _scatter_add(tgt, idx, src, axis=0):
    return tgt.clone().index_add_(axis, idx, src)
def _segment_sum(src, seg, n):
    out = torch.zeros((n,) + src.shape[1:], dtype=src.dtype)
    return out.index_add_(0, seg, src)
def _pad(x, pw):
    flat = tuple(v for pair in reversed(pw) for v in pair)
    return torch.nn.functional.pad(x, flat)

kernel_name = 'recurrent_scan__sliding_block_cached__dense_activation_squared_relu__prompt'

def setup_inputs():

    _w = (lambda a: (lambda t: t.to(torch.bfloat16) if t.is_floating_point() else t)(torch.as_tensor(a)))
    def _A_setup():
        B, Sq, D = 1, 2048, 512
        Hq, Hkv, Sk, Dh = 32, 32, 2048, 128
        assert Hq % Hkv == 0, (Hq, Hkv)
        return {
            "x": _w((lambda *s: torch.randn(*s, dtype=torch.bfloat16) * 0.05)(B, Sq, D)),
            "k_cache": _w((lambda *s: torch.randn(*s, dtype=torch.bfloat16) * 0.8)(B, Hkv, Sk, Dh)),
            "v_cache": _w((lambda *s: torch.randn(*s, dtype=torch.bfloat16) * 0.2)(B, Hkv, Sk, Dh)),
            "wq": _w((lambda *s: torch.randn(*s, dtype=torch.bfloat16) * 0.8)(D, Hq * Dh) * (D ** -0.5)),
            "wo": _w((lambda *s: torch.randn(*s, dtype=torch.bfloat16) * 0.2)(Hq * Dh, D) * ((Hq * Dh) ** -0.5)),
        }
    _A_in = _A_setup()

    def _B_setup():
        B, S, D, F = 1, 2048, 512, 1376
        return {
            "x": _w((lambda *s: torch.randn(*s, dtype=torch.bfloat16) * 0.05)(B, S, D)),
            "w1": _w((lambda *s: torch.randn(*s, dtype=torch.bfloat16) * 0.1)(D, F)),
            "b1": _w((lambda *s: torch.randn(*s, dtype=torch.bfloat16) * 0.8)(F)),
            "w2": _w((lambda *s: torch.randn(*s, dtype=torch.bfloat16) * 0.1)(F, D)),
            "b2": _w((lambda *s: torch.randn(*s, dtype=torch.bfloat16) * 6.4)(D)),
        }
    _B_in = _B_setup()

    return {
        "A_x": _A_in["x"],
        "A_k_cache": _A_in["k_cache"],
        "A_v_cache": _A_in["v_cache"],
        "A_wq": _A_in["wq"],
        "A_wo": _A_in["wo"],
        "B_x": _B_in["x"],
        "B_w1": _B_in["w1"],
        "B_b1": _B_in["b1"],
        "B_w2": _B_in["w2"],
        "B_b2": _B_in["b2"],
    }

def reference(A_x, A_k_cache, A_v_cache, A_wq, A_wo, B_x, B_w1, B_b1, B_w2, B_b2):
    def _A_ref(x, k_cache, v_cache, wq, wo):
        B, Sq, D = x.shape
        Hq, Dh = 32, 128
        Hkv, Sk = k_cache.shape[1], k_cache.shape[2]
        W = min(4096, max(256, Sk // 4))
        rep = Hq // Hkv
        q = (lambda x, *d: x.permute(*d))((x @ wq).reshape(B, Sq, Hq, Dh), 0, 2, 1, 3)
        k = (lambda x, n, axis: torch.repeat_interleave(x, n, dim=axis))(k_cache[:, :, Sk - W:, :], rep, axis=1)
        v = (lambda x, n, axis: torch.repeat_interleave(x, n, dim=axis))(v_cache[:, :, Sk - W:, :], rep, axis=1)
        scores = torch.einsum("bhqd,bhkd->bhqk", q, k) * (Dh ** -0.5)
        p = _softmax(scores, axis=-1)
        o = torch.einsum("bhqk,bhkd->bhqd", p, v)
        return (lambda x, *d: x.permute(*d))(o, 0, 2, 1, 3).reshape(B, Sq, Hq * Dh) @ wo

    def _B_ref(x, w1, b1, w2, b2):
        h = torch.einsum("bsd,df->bsf", x, w1) + b1
        zero = torch.zeros_like(h)
        r = torch.where(h > zero, h, zero)
        h = r * r
        out = torch.einsum("bsf,fd->bsd", h, w2) + b2
        return out

    x = A_x
    xn = _layernorm(x, axis=-1)
    s = _A_ref(xn, A_k_cache, A_v_cache, A_wq, A_wo)
    g = _silu(_B_ref(xn, B_w1, B_b1, B_w2, B_b2))
    return x + s * g
```

```asm
; @launch grid=(256,1,1) block=(512,1,1) lds=163840
.amdgcn_target "amdgcn-amd-amdhsa--gfx950"
.text
.globl recurrent_scan__sliding_block_cached__dense_activation_squared_relu__prompt_kernel
.p2align 8
.type recurrent_scan__sliding_block_cached__dense_activation_squared_relu__prompt_kernel,@function
recurrent_scan__sliding_block_cached__dense_activation_squared_relu__prompt_kernel:
  s_cmp_ge_u32 s2, 256
  s_cbranch_scc1 L_end
  s_load_dwordx2 s[40:41], s[0:1], 0
  s_load_dwordx4 s[56:59], s[0:1], 48
  s_load_dwordx2 s[52:53], s[0:1], 24
  s_load_dwordx2 s[42:43], s[0:1], 88
  s_memrealtime s[96:97]
  s_load_dwordx2 s[54:55], s[0:1], 96
  s_load_dwordx4 s[48:51], s[0:1], 8
  s_load_dwordx2 s[4:5], s[0:1], 32
  s_load_dwordx2 s[6:7], s[0:1], 64
  v_lshrrev_b32 v2, 6, v0
  v_and_b32 v1, 63, v0
  v_readfirstlane_b32 s36, v2
  s_and_b32 s37, s2, 7
  s_lshl_b32 s37, s37, 2
  s_lshr_b32 s38, s2, 3
  s_and_b32 s39, s38, 3
  s_add_u32 s37, s37, s39
  s_lshr_b32 s38, s38, 2
  s_and_b32 s39, s37, 1
  s_mul_i32 s47, s37, 3
  s_sub_u32 s47, s47, s39
  s_lshl_b32 s60, s37, 1
  s_add_u32 s60, s60, 22
  s_cmp_lt_u32 s37, 22
  s_cselect_b32 s47, s47, s60
  s_cselect_b32 s39, s39, 0
  v_lshrrev_b32 v24, 4, v1
  v_and_b32 v25, 15, v1
  s_lshl_b32 s60, s38, 8
  s_lshl_b32 s61, s36, 5
  s_add_u32 s60, s60, s61
  s_lshl_b32 s60, s60, 10
  s_lshl_b32 s61, s39, 14
  s_add_u32 s62, s60, s61
  s_sub_u32 s60, s60, s61
  s_add_u32 s60, s60, 16384
  v_lshrrev_b32 v28, 3, v1
  v_lshlrev_b32 v29, 10, v28
  v_and_b32 v30, 7, v1
  v_xor_b32 v31, v30, v24
  v_lshl_add_u32 v29, v31, 4, v29
  v_xor_b32 v31, 64, v29
  v_add_u32 v31, 8192, v31
  v_add_u32 v2, s62, v29
  v_add_u32 v3, s62, v31
  v_add_u32 v4, s60, v29
  v_add_u32 v5, s60, v31
  s_lshl_b32 s61, s36, 3
  v_add_u32 v28, s61, v28
  v_and_b32 v29, 2, v28
  v_lshrrev_b32 v31, 1, v28
  v_and_b32 v31, 4, v31
  v_or_b32 v29, v29, v31
  v_xor_b32 v29, v29, v30
  v_lshlrev_b32 v29, 4, v29
  v_mul_u32_u24 v28, 2752, v28
  s_lshl_b32 s61, s47, 5
  v_add3_u32 v7, v28, v29, s61
  s_lshl_b32 s61, s36, 2
  v_add_u32 v26, s61, v24
  v_lshrrev_b32 v28, 1, v26
  v_and_b32 v28, 4, v28
  v_or_b32 v28, v28, v24
  v_lshlrev_b32 v28, 1, v28
  v_xor_b32 v28, v28, v25
  v_lshlrev_b32 v28, 4, v28
  v_lshl_add_u32 v6, v26, 13, v28
  s_lshl_b32 s61, s37, 8
  v_add_u32 v6, s61, v6
  s_lshl_b32 s45, s36, 10
  s_lshl_b32 s44, s36, 13
  s_add_u32 s44, s44, 98304
  v_lshlrev_b32 v27, 4, v1
  s_and_b32 s46, s38, 3
  s_lshl_b32 s46, s46, 1
  s_add_u32 s64, s46, 0
  s_and_b32 s64, s64, 7
  s_mul_i32 s67, s64, 176128
  s_lshl_b32 s65, s64, 19
  s_add_u32 s66, s65, 262144
  s_lshl_b32 s64, s64, 7
  s_lshl_b32 s60, s38, 8
  s_lshl_b32 s61, s37, 3
  s_add_u32 s60, s60, s61
  s_add_u32 s3, s60, s36
  s_lshl_b32 s63, s3, 10
  s_waitcnt lgkmcnt(0)
  s_mov_b32 s8, s40
  s_mov_b32 s9, s41
  s_mov_b32 s10, 2097152
  s_mov_b32 s11, 0x20000
  s_mov_b32 s16, s56
  s_mov_b32 s17, s57
  s_mov_b32 s18, 1409024
  s_mov_b32 s19, 0x20000
  s_mov_b32 s12, s52
  s_mov_b32 s13, s53
  s_mov_b32 s14, 4194304
  s_mov_b32 s15, 0x20000
  s_add_u32 m0, s44, 0
  s_nop 0
  buffer_load_dwordx4 v2, s[8:11], s64 offen lds
  s_add_u32 m0, s44, 1024
  s_nop 0
  buffer_load_dwordx4 v3, s[8:11], s64 offen lds
  s_add_u32 m0, s44, 2048
  s_nop 0
  buffer_load_dwordx4 v4, s[8:11], s64 offen lds
  s_add_u32 m0, s44, 3072
  s_nop 0
  buffer_load_dwordx4 v5, s[8:11], s64 offen lds
  s_add_u32 m0, s45, 73728
  s_nop 0
  buffer_load_dwordx4 v7, s[16:19], s67 offen lds
  buffer_load_dwordx4 v[236:239], v27, s[8:11], s63 offen
  s_add_u32 m0, s45, 24576
  s_nop 0
  buffer_load_dwordx4 v6, s[12:15], s65 offen lds
  s_or_b32 s96, s96, 1
  v_mov_b32 v234, s96
  v_mov_b32 v233, 0
  s_or_b32 s61, s2, s36
  s_cselect_b64 exec, 0, 1
  global_store_dword v233, v234, s[42:43] sc0 sc1
  s_mov_b64 exec, -1
  s_add_u32 s68, s46, 1
  s_and_b32 s68, s68, 7
  s_mul_i32 s71, s68, 176128
  s_lshl_b32 s69, s68, 19
  s_add_u32 s70, s69, 262144
  s_lshl_b32 s68, s68, 7
  s_add_u32 s72, s46, 2
  s_and_b32 s72, s72, 7
  s_mul_i32 s75, s72, 176128
  s_lshl_b32 s73, s72, 19
  s_add_u32 s74, s73, 262144
  s_lshl_b32 s72, s72, 7
  s_add_u32 s76, s46, 3
  s_and_b32 s76, s76, 7
  s_mul_i32 s79, s76, 176128
  s_lshl_b32 s77, s76, 19
  s_add_u32 s78, s77, 262144
  s_lshl_b32 s76, s76, 7
  s_add_u32 s80, s46, 4
  s_and_b32 s80, s80, 7
  s_mul_i32 s83, s80, 176128
  s_lshl_b32 s81, s80, 19
  s_add_u32 s82, s81, 262144
  s_lshl_b32 s80, s80, 7
  s_add_u32 s84, s46, 5
  s_and_b32 s84, s84, 7
  s_mul_i32 s87, s84, 176128
  s_lshl_b32 s85, s84, 19
  s_add_u32 s86, s85, 262144
  s_lshl_b32 s84, s84, 7
  s_add_u32 s88, s46, 6
  s_and_b32 s88, s88, 7
  s_mul_i32 s91, s88, 176128
  s_lshl_b32 s89, s88, 19
  s_add_u32 s90, s89, 262144
  s_lshl_b32 s88, s88, 7
  s_add_u32 s92, s46, 7
  s_and_b32 s92, s92, 7
  s_mul_i32 s95, s92, 176128
  s_lshl_b32 s93, s92, 19
  s_add_u32 s94, s93, 262144
  s_lshl_b32 s92, s92, 7
  s_mov_b32 s20, s48
  s_mov_b32 s21, s49
  s_mov_b32 s22, 16777216
  s_mov_b32 s23, 0x20000
  s_mov_b32 s24, s50
  s_mov_b32 s25, s51
  s_mov_b32 s26, 16777216
  s_mov_b32 s27, 0x20000
  s_mov_b32 s32, s58
  s_mov_b32 s33, s59
  s_mov_b32 s34, 2752
  s_mov_b32 s35, 0x20000
  s_mov_b32 s28, s54
  s_mov_b32 s29, s55
  s_mov_b32 s30, 268435456
  s_mov_b32 s31, 0x20000
  s_lshl_b32 s46, s37, 19
  s_add_u32 s46, s46, 393216
  v_and_b32 v28, 15, v26
  v_xor_b32 v28, v28, v25
  v_lshlrev_b32 v28, 4, v28
  v_lshl_add_u32 v8, v26, 8, v28
  v_and_b32 v28, 7, v26
  v_lshlrev_b32 v28, 1, v28
  v_xor_b32 v28, v28, v25
  v_lshlrev_b32 v28, 4, v28
  v_lshl_add_u32 v9, v26, 8, v28
  v_lshrrev_b32 v28, 1, v25
  v_xor_b32 v28, v28, v24
  v_lshlrev_b32 v28, 4, v28
  v_lshl_add_u32 v28, v25, 7, v28
  v_add_u32 v10, s44, v28
  v_xor_b32 v11, 64, v10
  v_bfe_u32 v240, v1, 2, 2
  v_and_b32 v241, 3, v1
  v_lshlrev_b32 v241, 3, v241
  v_and_b32 v242, 1, v24
  v_lshl_add_u32 v28, v242, 2, v240
  v_lshl_add_u32 v28, v28, 5, v241
  v_lshl_add_u32 v243, v24, 3, v240
  v_lshl_add_u32 v12, v243, 8, v28
  v_xor_b32 v13, 32, v12
  v_xor_b32 v14, 64, v12
  v_xor_b32 v15, 96, v12
  v_xor_b32 v16, 128, v12
  v_xor_b32 v17, 160, v12
  v_xor_b32 v18, 192, v12
  v_xor_b32 v19, 224, v12
  v_lshrrev_b32 v28, 1, v240
  v_lshl_add_u32 v28, v242, 1, v28
  v_lshl_add_u32 v28, v28, 5, v241
  v_lshl_add_u32 v28, v243, 7, v28
  v_add_u32 v28, 73728, v28
  s_lshl_b32 s60, s39, 6
  v_xor_b32 v32, s60, v28
  v_xor_b32 v33, 32, v32
  v_xor_b32 v34, 64, v32
  v_xor_b32 v35, 96, v32
  v_xor_b32 v28, v25, v24
  v_lshlrev_b32 v28, 4, v28
  v_lshl_add_u32 v20, v25, 8, v28
  v_xor_b32 v21, 64, v20
  v_xor_b32 v22, 128, v20
  v_xor_b32 v23, 192, v20
  v_lshlrev_b32 v26, 10, v24
  v_sub_u32 v26, 65536, v26
  s_lshl_b32 s60, s36, 5
  v_xor_b32 v30, s60, v12
  s_and_b32 s60, s60, 0x60
  v_xor_b32 v31, s60, v32
  s_lshr_b32 s60, s36, 1
  s_lshl_b32 s61, s39, 1
  s_xor_b32 s60, s60, s61
  s_add_u32 s60, s60, s47
  s_lshl_b32 s60, s60, 5
  s_and_b32 s61, s36, 1
  s_lshl_b32 s61, s61, 4
  s_add_u32 s60, s60, s61
  v_lshrrev_b32 v28, 2, v1
  v_and_b32 v240, 7, v1
  v_cmp_eq_u32 vcc, 0, v240
  s_nop 1
  v_cndmask_b32 v28, -1, v28, vcc
  buffer_load_ushort v252, v28, s[32:35], s60 offen
  v_cmp_eq_u32 s[54:55], 1, v25
  v_cmp_eq_u32 s[56:57], 2, v25
  v_cmp_eq_u32 s[58:59], 3, v25
  s_lshl_b32 s60, s38, 4
  s_lshl_b32 s61, s36, 1
  s_add_u32 s60, s60, s61
  s_add_u32 s60, s60, s39
  s_xor_b32 s61, s60, 1
  s_lshl_b32 s62, s37, 12
  s_add_u32 s62, s62, 4194304
  s_lshl_b32 s52, s60, 17
  s_add_u32 s52, s52, s62
  s_lshl_b32 s53, s61, 17
  s_add_u32 s53, s53, s62
  s_lshl_b32 s35, s60, 7
  s_add_u32 s35, s35, 46137344
  s_xor_b32 s51, s35, 128
  s_mul_i32 s60, s60, 44032
  s_mul_i32 s61, s61, 44032
  s_lshl_b32 s62, s47, 9
  s_add_u32 s62, s62, 25165824
  s_lshl_b32 s63, s39, 10
  s_add_u32 s48, s60, s62
  s_add_u32 s49, s61, s62
  s_sub_u32 s50, s48, s63
  s_add_u32 s50, s50, 1024
  s_add_u32 s48, s48, s63
  s_add_u32 s49, s49, s63
  s_cmp_ge_u32 s37, 22
  s_cselect_b32 s50, 0x40000000, s50
  v_lshl_add_u32 v232, v24, 2, v25
  v_lshlrev_b32 v232, 3, v232
  v_cmp_gt_u32 vcc, 4, v25
  s_nop 1
  v_cndmask_b32 v232, -1, v232, vcc
  s_mul_i32 s60, s37, 12288
  s_add_u32 s60, s60, 47185920
  s_lshl_b32 s40, s36, 7
  s_add_u32 s40, s40, s60
  s_mul_i32 s61, s38, 1536
  s_add_u32 s40, s40, s61
  s_add_u32 s41, s40, 1024
  s_cmp_lt_u32 s36, 4
  s_cselect_b32 s41, s41, 0x40000000
  s_lshl_b32 s3, s3, 3
  s_add_u32 s3, s3, 46137344
  s_lshl_b32 s61, s36, 6
  s_add_u32 s32, s60, s61
  v_mul_u32_u24 v253, 1536, v240
  v_lshrrev_b32 v241, 3, v1
  v_lshl_add_u32 v253, v241, 3, v253
  v_lshlrev_b32 v233, 3, v25
  v_lshlrev_b32 v234, 6, v241
  v_lshrrev_b32 v241, 1, v240
  v_lshl_add_u32 v234, v241, 4, v234
  v_and_b32 v240, 1, v240
  v_lshl_add_u32 v234, v240, 2, v234
  s_lshl_b32 s61, s36, 9
  s_add_u32 s61, s61, 147456
  v_add_u32 v234, s61, v234
  v_lshlrev_b32 v235, 6, v25
  v_lshl_add_u32 v235, v24, 4, v235
  v_add_u32 v235, 147456, v235
  v_mov_b32 v28, 0
  s_waitcnt vmcnt(3)
  v_lshlrev_b32 v240, 16, v236
  v_and_b32 v241, 0xffff0000, v236
  v_lshlrev_b32 v242, 16, v237
  v_and_b32 v243, 0xffff0000, v237
  v_lshlrev_b32 v244, 16, v238
  v_and_b32 v245, 0xffff0000, v238
  v_lshlrev_b32 v246, 16, v239
  v_and_b32 v247, 0xffff0000, v239
  v_add_f32 v248, v240, v241
  v_add_f32 v249, v242, v243
  v_add_f32 v236, v244, v245
  v_add_f32 v237, v246, v247
  v_add_f32 v248, v248, v249
  v_add_f32 v236, v236, v237
  v_add_f32 v248, v248, v236
  s_nop 1
  v_add_f32_dpp v248, v248, v248 quad_perm:[1,0,3,2] row_mask:0xf bank_mask:0xf
  s_nop 1
  v_add_f32_dpp v248, v248, v248 quad_perm:[2,3,0,1] row_mask:0xf bank_mask:0xf
  s_nop 1
  v_add_f32_dpp v248, v248, v248 row_half_mirror row_mask:0xf bank_mask:0xf
  s_nop 1
  v_add_f32_dpp v248, v248, v248 row_mirror row_mask:0xf bank_mask:0xf
  v_mov_b32 v249, v248
  s_nop 1
  v_permlane16_swap_b32 v248, v249
  v_add_f32 v248, v248, v249
  v_mov_b32 v249, v248
  s_nop 1
  v_permlane32_swap_b32 v248, v249
  v_add_f32 v248, v248, v249
  v_mul_f32 v248, 0x3b000000, v248
  v_sub_f32 v240, v240, v248
  v_sub_f32 v241, v241, v248
  v_sub_f32 v242, v242, v248
  v_sub_f32 v243, v243, v248
  v_sub_f32 v244, v244, v248
  v_sub_f32 v245, v245, v248
  v_sub_f32 v246, v246, v248
  v_sub_f32 v247, v247, v248
  v_mul_f32 v250, v240, v240
  v_mul_f32 v236, v241, v241
  v_fmac_f32 v250, v242, v242
  v_fmac_f32 v236, v243, v243
  v_fmac_f32 v250, v244, v244
  v_fmac_f32 v236, v245, v245
  v_fmac_f32 v250, v246, v246
  v_fmac_f32 v236, v247, v247
  v_add_f32 v250, v250, v236
  s_nop 1
  v_add_f32_dpp v250, v250, v250 quad_perm:[1,0,3,2] row_mask:0xf bank_mask:0xf
  s_nop 1
  v_add_f32_dpp v250, v250, v250 quad_perm:[2,3,0,1] row_mask:0xf bank_mask:0xf
  s_nop 1
  v_add_f32_dpp v250, v250, v250 row_half_mirror row_mask:0xf bank_mask:0xf
  s_nop 1
  v_add_f32_dpp v250, v250, v250 row_mirror row_mask:0xf bank_mask:0xf
  v_mov_b32 v249, v250
  s_nop 1
  v_permlane16_swap_b32 v250, v249
  v_add_f32 v250, v250, v249
  v_mov_b32 v249, v250
  s_nop 1
  v_permlane32_swap_b32 v250, v249
  v_add_f32 v250, v250, v249
  v_mul_f32 v250, 0x3b000000, v250
  v_cvt_pk_bf16_f32 v250, v250, v250
  v_lshlrev_b32 v250, 16, v250
  v_add_f32 v250, 0x3727c5ac, v250
  v_cvt_pk_bf16_f32 v250, v250, v250
  v_lshlrev_b32 v250, 16, v250
  v_sqrt_f32 v250, v250
  s_nop 0
  v_cvt_pk_bf16_f32 v250, v248, v250
  s_cmp_lt_u32 s38, 4
  s_cselect_b32 s60, 0x3f803f80, 0
  s_xor_b32 s61, s60, 0x3f803f80
  v_mov_b32 v220, s60
  v_mov_b32 v244, s61
  v_mov_b32 v221, s60
  v_mov_b32 v245, s61
  v_mov_b32 v222, s60
  v_mov_b32 v246, s61
  v_mov_b32 v223, s60
  v_mov_b32 v247, s61
  s_add_u32 m0, s45, 32768
  s_nop 0
  buffer_load_dwordx4 v6, s[12:15], s66 offen lds
  s_add_u32 m0, s44, 4096
  s_nop 0
  buffer_load_dwordx4 v2, s[8:11], s68 offen lds
  s_add_u32 m0, s44, 5120
  s_nop 0
  buffer_load_dwordx4 v3, s[8:11], s68 offen lds
  s_add_u32 m0, s44, 6144
  s_nop 0
  buffer_load_dwordx4 v4, s[8:11], s68 offen lds
  s_add_u32 m0, s44, 7168
  s_nop 0
  buffer_load_dwordx4 v5, s[8:11], s68 offen lds
  s_add_u32 m0, s45, 81920
  s_nop 0
  buffer_load_dwordx4 v7, s[16:19], s71 offen lds
  ds_read_b128 v[156:159], v10 offset:0
  ds_read_b128 v[160:163], v10 offset:2048
  ds_read_b128 v[164:167], v11 offset:0
  ds_read_b128 v[168:171], v11 offset:2048
  s_barrier
  ds_read_b64_tr_b16 v[36:37], v32 offset:0
  ds_read_b64_tr_b16 v[38:39], v32 offset:512
  ds_read_b64_tr_b16 v[40:41], v33 offset:0
  ds_read_b64_tr_b16 v[42:43], v33 offset:512
  ds_read_b64_tr_b16 v[44:45], v34 offset:0
  ds_read_b64_tr_b16 v[46:47], v34 offset:512
  ds_read_b64_tr_b16 v[48:49], v35 offset:0
  ds_read_b64_tr_b16 v[50:51], v35 offset:512
  ds_read_b64_tr_b16 v[52:53], v31 offset:0
  ds_read_b64_tr_b16 v[54:55], v31 offset:512
  s_waitcnt lgkmcnt(6)
  v_mfma_f32_16x16x32_bf16 v[132:135], v[36:39], v[156:159], 0
  ds_read_b64_tr_b16 v[56:57], v32 offset:4096
  v_mfma_f32_16x16x32_bf16 v[136:139], v[36:39], v[160:163], 0
  s_add_u32 m0, s44, 0
  ds_read_b64_tr_b16 v[58:59], v32 offset:4608
  buffer_load_dwordx4 v2, s[8:11], s72 offen lds
  v_mfma_f32_16x16x32_bf16 v[140:143], v[40:43], v[156:159], 0
  ds_read_b64_tr_b16 v[60:61], v33 offset:4096
  v_mfma_f32_16x16x32_bf16 v[144:147], v[40:43], v[160:163], 0
  ds_read_b64_tr_b16 v[62:63], v33 offset:4608
  s_waitcnt lgkmcnt(6)
  v_mfma_f32_16x16x32_bf16 v[148:151], v[44:47], v[156:159], 0
  s_add_u32 m0, s44, 1024
  ds_read_b64_tr_b16 v[64:65], v34 offset:4096
  ds_read_b64_tr_b16 v[66:67], v34 offset:4608
  buffer_load_dwordx4 v3, s[8:11], s72 offen lds
  v_mfma_f32_16x16x32_bf16 v[152:155], v[48:51], v[156:159], 0
  ds_read_b64_tr_b16 v[36:37], v35 offset:4096
  ds_read_b64_tr_b16 v[38:39], v35 offset:4608
  s_waitcnt lgkmcnt(8)
  v_mfma_f32_16x16x32_bf16 v[228:231], v[52:55], v[220:223], 0
  ds_read_b64_tr_b16 v[40:41], v31 offset:4096
  ds_read_b64_tr_b16 v[42:43], v31 offset:4608
  s_waitcnt lgkmcnt(8)
  v_mfma_f32_16x16x32_bf16 v[132:135], v[56:59], v[164:167], v[132:135]
  s_waitcnt vmcnt(10)
  s_barrier
  s_add_u32 m0, s44, 2048
  ds_read_b64_tr_b16 v[44:45], v12 offset:24576
  buffer_load_dwordx4 v4, s[8:11], s72 offen lds
  v_mfma_f32_16x16x32_bf16 v[136:139], v[56:59], v[168:171], v[136:139]
  ds_read_b64_tr_b16 v[46:47], v12 offset:25600
  s_waitcnt lgkmcnt(6)
  v_mfma_f32_16x16x32_bf16 v[140:143], v[60:63], v[164:167], v[140:143]
  ds_read_b64_tr_b16 v[48:49], v13 offset:24576
  v_mfma_f32_16x16x32_bf16 v[144:147], v[60:63], v[168:171], v[144:147]
  s_add_u32 m0, s44, 3072
  ds_read_b64_tr_b16 v[50:51], v13 offset:25600
  buffer_load_dwordx4 v5, s[8:11], s72 offen lds
  v_mfma_f32_16x16x32_bf16 v[148:151], v[64:67], v[164:167], v[148:151]
  ds_read_b64_tr_b16 v[52:53], v14 offset:24576
  ds_read_b64_tr_b16 v[54:55], v14 offset:25600
  s_waitcnt lgkmcnt(6)
  v_mfma_f32_16x16x32_bf16 v[152:155], v[36:39], v[164:167], v[152:155]
  ds_read_b64_tr_b16 v[56:57], v15 offset:24576
  ds_read_b64_tr_b16 v[58:59], v15 offset:25600
  v_mfma_f32_16x16x32_bf16 v[228:231], v[40:43], v[220:223], v[228:231]
  s_add_u32 m0, s45, 40960
  ds_read_b64_tr_b16 v[60:61], v16 offset:24576
  ds_read_b64_tr_b16 v[62:63], v16 offset:25600
  buffer_load_dwordx4 v6, s[12:15], s69 offen lds
  s_waitcnt lgkmcnt(6)
  v_mfma_f32_16x16x32_bf16 v[68:71], v[44:47], v[156:159], 0
  ds_read_b64_tr_b16 v[64:65], v17 offset:24576
  v_mfma_f32_16x16x32_bf16 v[72:75], v[44:47], v[160:163], 0
  ds_read_b64_tr_b16 v[66:67], v17 offset:25600
  v_mfma_f32_16x16x32_bf16 v[76:79], v[48:51], v[156:159], 0
  s_add_u32 m0, s45, 90112
  ds_read_b64_tr_b16 v[36:37], v18 offset:24576
  buffer_load_dwordx4 v7, s[16:19], s75 offen lds
  v_mfma_f32_16x16x32_bf16 v[80:83], v[48:51], v[160:163], 0
  ds_read_b64_tr_b16 v[38:39], v18 offset:25600
  s_waitcnt lgkmcnt(6)
  v_mfma_f32_16x16x32_bf16 v[84:87], v[52:55], v[156:159], 0
  ds_read_b64_tr_b16 v[40:41], v19 offset:24576
  v_mfma_f32_16x16x32_bf16 v[88:91], v[52:55], v[160:163], 0
  s_add_u32 m0, s45, 49152
  ds_read_b64_tr_b16 v[42:43], v19 offset:25600
  buffer_load_dwordx4 v6, s[12:15], s70 offen lds
  v_mfma_f32_16x16x32_bf16 v[92:95], v[56:59], v[156:159], 0
  ds_read_b64_tr_b16 v[44:45], v30 offset:24576
  s_waitcnt vmcnt(8)
  ds_read_b128 v[172:175], v10 offset:4096
  v_mfma_f32_16x16x32_bf16 v[96:99], v[56:59], v[160:163], 0
  ds_read_b64_tr_b16 v[46:47], v30 offset:25600
  s_waitcnt lgkmcnt(7)
  v_mfma_f32_16x16x32_bf16 v[100:103], v[60:63], v[156:159], 0
  s_waitcnt vmcnt(7)
  s_barrier
  ds_read_b64_tr_b16 v[48:49], v12 offset:32768
  v_mfma_f32_16x16x32_bf16 v[104:107], v[60:63], v[160:163], 0
  s_add_u32 m0, s45, 73728
  ds_read_b64_tr_b16 v[50:51], v12 offset:33792
  buffer_load_dwordx4 v7, s[16:19], s79 offen lds
  ds_read_b128 v[176:179], v10 offset:6144
  v_mfma_f32_16x16x32_bf16 v[108:111], v[64:67], v[156:159], 0
  ds_read_b64_tr_b16 v[52:53], v13 offset:32768
  v_mfma_f32_16x16x32_bf16 v[112:115], v[64:67], v[160:163], 0
  ds_read_b64_tr_b16 v[54:55], v13 offset:33792
  s_waitcnt lgkmcnt(8)
  v_mfma_f32_16x16x32_bf16 v[116:119], v[36:39], v[156:159], 0
  s_add_u32 m0, s45, 57344
  ds_read_b64_tr_b16 v[56:57], v14 offset:32768
  buffer_load_dwordx4 v6, s[12:15], s73 offen lds
  ds_read_b128 v[180:183], v11 offset:4096
  v_mfma_f32_16x16x32_bf16 v[120:123], v[36:39], v[160:163], 0
  ds_read_b64_tr_b16 v[58:59], v14 offset:33792
  v_mfma_f32_16x16x32_bf16 v[124:127], v[40:43], v[156:159], 0
  ds_read_b64_tr_b16 v[60:61], v15 offset:32768
  v_mfma_f32_16x16x32_bf16 v[128:131], v[40:43], v[160:163], 0
  ds_read_b64_tr_b16 v[62:63], v15 offset:33792
  ds_read_b128 v[184:187], v11 offset:6144
  s_waitcnt lgkmcnt(11)
  v_mfma_f32_16x16x32_bf16 v[224:227], v[44:47], v[220:223], 0
  ds_read_b64_tr_b16 v[64:65], v16 offset:32768
  ds_read_b64_tr_b16 v[66:67], v16 offset:33792
  s_waitcnt lgkmcnt(11)
  v_mfma_f32_16x16x32_bf16 v[68:71], v[48:51], v[164:167], v[68:71]
  ds_read_b64_tr_b16 v[36:37], v17 offset:32768
  v_mfma_f32_16x16x32_bf16 v[72:75], v[48:51], v[168:171], v[72:75]
  ds_read_b64_tr_b16 v[38:39], v17 offset:33792
  s_waitcnt lgkmcnt(7)
  v_mfma_f32_16x16x32_bf16 v[76:79], v[52:55], v[164:167], v[76:79]
  ds_read_b64_tr_b16 v[40:41], v18 offset:32768
  v_mfma_f32_16x16x32_bf16 v[80:83], v[52:55], v[168:171], v[80:83]
  ds_read_b64_tr_b16 v[42:43], v18 offset:33792
  v_mfma_f32_16x16x32_bf16 v[84:87], v[56:59], v[164:167], v[84:87]
  ds_read_b64_tr_b16 v[44:45], v19 offset:32768
  v_mfma_f32_16x16x32_bf16 v[88:91], v[56:59], v[168:171], v[88:91]
  ds_read_b64_tr_b16 v[46:47], v19 offset:33792
  s_waitcnt lgkmcnt(6)
  v_mfma_f32_16x16x32_bf16 v[92:95], v[60:63], v[164:167], v[92:95]
  ds_read_b64_tr_b16 v[48:49], v30 offset:32768
  v_mfma_f32_16x16x32_bf16 v[96:99], v[60:63], v[168:171], v[96:99]
  ds_read_b64_tr_b16 v[50:51], v30 offset:33792
  v_mfma_f32_16x16x32_bf16 v[100:103], v[64:67], v[164:167], v[100:103]
  ds_read_b64_tr_b16 v[52:53], v32 offset:8192
  v_mfma_f32_16x16x32_bf16 v[104:107], v[64:67], v[168:171], v[104:107]
  ds_read_b64_tr_b16 v[54:55], v32 offset:8704
  s_waitcnt lgkmcnt(6)
  v_mfma_f32_16x16x32_bf16 v[108:111], v[36:39], v[164:167], v[108:111]
  ds_read_b64_tr_b16 v[56:57], v33 offset:8192
  v_mfma_f32_16x16x32_bf16 v[112:115], v[36:39], v[168:171], v[112:115]
  s_add_u32 m0, s44, 4096
  ds_read_b64_tr_b16 v[58:59], v33 offset:8704
  buffer_load_dwordx4 v2, s[8:11], s76 offen lds
  v_mfma_f32_16x16x32_bf16 v[116:119], v[40:43], v[164:167], v[116:119]
  ds_read_b64_tr_b16 v[60:61], v34 offset:8192
  v_mfma_f32_16x16x32_bf16 v[120:123], v[40:43], v[168:171], v[120:123]
  ds_read_b64_tr_b16 v[62:63], v34 offset:8704
  s_waitcnt lgkmcnt(6)
  v_mfma_f32_16x16x32_bf16 v[124:127], v[44:47], v[164:167], v[124:127]
  s_add_u32 m0, s44, 5120
  ds_read_b64_tr_b16 v[64:65], v35 offset:8192
  buffer_load_dwordx4 v3, s[8:11], s76 offen lds
  v_mfma_f32_16x16x32_bf16 v[128:131], v[44:47], v[168:171], v[128:131]
  ds_read_b64_tr_b16 v[66:67], v35 offset:8704
  v_mfma_f32_16x16x32_bf16 v[224:227], v[48:51], v[220:223], v[224:227]
  ds_read_b64_tr_b16 v[36:37], v31 offset:8192
  ds_read_b64_tr_b16 v[38:39], v31 offset:8704
  s_waitcnt lgkmcnt(6)
  v_mfma_f32_16x16x32_bf16 v[132:135], v[52:55], v[172:175], v[132:135]
  s_add_u32 m0, s44, 6144
  ds_read_b64_tr_b16 v[40:41], v32 offset:12288
  buffer_load_dwordx4 v4, s[8:11], s76 offen lds
  v_mfma_f32_16x16x32_bf16 v[136:139], v[52:55], v[176:179], v[136:139]
  ds_read_b64_tr_b16 v[42:43], v32 offset:12800
  v_mfma_f32_16x16x32_bf16 v[140:143], v[56:59], v[172:175], v[140:143]
  ds_read_b64_tr_b16 v[44:45], v33 offset:12288
  v_mfma_f32_16x16x32_bf16 v[144:147], v[56:59], v[176:179], v[144:147]
  s_add_u32 m0, s44, 7168
  ds_read_b64_tr_b16 v[46:47], v33 offset:12800
  buffer_load_dwordx4 v5, s[8:11], s76 offen lds
  s_waitcnt vmcnt(9)
  ds_read_b128 v[188:191], v10 offset:0
  s_waitcnt lgkmcnt(7)
  v_mfma_f32_16x16x32_bf16 v[148:151], v[60:63], v[172:175], v[148:151]
  ds_read_b64_tr_b16 v[48:49], v34 offset:12288
  ds_read_b64_tr_b16 v[50:51], v34 offset:12800
  v_mfma_f32_16x16x32_bf16 v[152:155], v[64:67], v[172:175], v[152:155]
  ds_read_b64_tr_b16 v[52:53], v35 offset:12288
  ds_read_b64_tr_b16 v[54:55], v35 offset:12800
  s_waitcnt lgkmcnt(9)
  v_mfma_f32_16x16x32_bf16 v[228:231], v[36:39], v[244:247], v[228:231]
  ds_read_b64_tr_b16 v[56:57], v31 offset:12288
  ds_read_b64_tr_b16 v[58:59], v31 offset:12800
  ds_read_b128 v[192:195], v10 offset:2048
  s_waitcnt lgkmcnt(10)
  v_mfma_f32_16x16x32_bf16 v[132:135], v[40:43], v[180:183], v[132:135]
  s_waitcnt vmcnt(7)
  s_barrier
  ds_read_b64_tr_b16 v[60:61], v12 offset:40960
  v_mfma_f32_16x16x32_bf16 v[136:139], v[40:43], v[184:187], v[136:139]
  s_add_u32 m0, s45, 24576
  ds_read_b64_tr_b16 v[62:63], v12 offset:41984
  buffer_load_dwordx4 v6, s[12:15], s74 offen lds
  s_waitcnt lgkmcnt(7)
  v_mfma_f32_16x16x32_bf16 v[140:143], v[44:47], v[180:183], v[140:143]
  ds_read_b64_tr_b16 v[64:65], v13 offset:40960
  ds_read_b128 v[196:199], v11 offset:0
  v_mfma_f32_16x16x32_bf16 v[144:147], v[44:47], v[184:187], v[144:147]
  ds_read_b64_tr_b16 v[66:67], v13 offset:41984
  v_mfma_f32_16x16x32_bf16 v[148:151], v[48:51], v[180:183], v[148:151]
  s_add_u32 m0, s45, 32768
  ds_read_b64_tr_b16 v[36:37], v14 offset:40960
  ds_read_b64_tr_b16 v[38:39], v14 offset:41984
  buffer_load_dwordx4 v6, s[12:15], s77 offen lds
  s_waitcnt lgkmcnt(8)
  v_mfma_f32_16x16x32_bf16 v[152:155], v[52:55], v[180:183], v[152:155]
  ds_read_b64_tr_b16 v[40:41], v15 offset:40960
  ds_read_b64_tr_b16 v[42:43], v15 offset:41984
  ds_read_b128 v[200:203], v11 offset:2048
  v_mfma_f32_16x16x32_bf16 v[228:231], v[56:59], v[244:247], v[228:231]
  ds_read_b64_tr_b16 v[44:45], v16 offset:40960
  ds_read_b64_tr_b16 v[46:47], v16 offset:41984
  s_waitcnt lgkmcnt(7)
  v_mfma_f32_16x16x32_bf16 v[68:71], v[60:63], v[172:175], v[68:71]
  ds_read_b64_tr_b16 v[48:49], v17 offset:40960
  v_mfma_f32_16x16x32_bf16 v[72:75], v[60:63], v[176:179], v[72:75]
  ds_read_b64_tr_b16 v[50:51], v17 offset:41984
  v_mfma_f32_16x16x32_bf16 v[76:79], v[64:67], v[172:175], v[76:79]
  ds_read_b64_tr_b16 v[52:53], v18 offset:40960
  v_mfma_f32_16x16x32_bf16 v[80:83], v[64:67], v[176:179], v[80:83]
  ds_read_b64_tr_b16 v[54:55], v18 offset:41984
  s_waitcnt lgkmcnt(7)
  v_mfma_f32_16x16x32_bf16 v[84:87], v[36:39], v[172:175], v[84:87]
  ds_read_b64_tr_b16 v[56:57], v19 offset:40960
  v_mfma_f32_16x16x32_bf16 v[88:91], v[36:39], v[176:179], v[88:91]
  ds_read_b64_tr_b16 v[58:59], v19 offset:41984
  global_load_dword v251, v28, s[42:43] sc0 sc1
  v_mfma_f32_16x16x32_bf16 v[92:95], v[40:43], v[172:175], v[92:95]
  ds_read_b64_tr_b16 v[60:61], v30 offset:40960
  v_mfma_f32_16x16x32_bf16 v[96:99], v[40:43], v[176:179], v[96:99]
  ds_read_b64_tr_b16 v[62:63], v30 offset:41984
  s_waitcnt lgkmcnt(6)
  v_mfma_f32_16x16x32_bf16 v[100:103], v[44:47], v[172:175], v[100:103]
  ds_read_b64_tr_b16 v[64:65], v32 offset:16384
  v_mfma_f32_16x16x32_bf16 v[104:107], v[44:47], v[176:179], v[104:107]
  ds_read_b64_tr_b16 v[66:67], v32 offset:16896
  v_mfma_f32_16x16x32_bf16 v[108:111], v[48:51], v[172:175], v[108:111]
  ds_read_b64_tr_b16 v[36:37], v33 offset:16384
  v_mfma_f32_16x16x32_bf16 v[112:115], v[48:51], v[176:179], v[112:115]
  s_add_u32 m0, s44, 0
  ds_read_b64_tr_b16 v[38:39], v33 offset:16896
  buffer_load_dwordx4 v2, s[8:11], s80 offen lds
  s_waitcnt lgkmcnt(6)
  v_mfma_f32_16x16x32_bf16 v[116:119], v[52:55], v[172:175], v[116:119]
  ds_read_b64_tr_b16 v[40:41], v34 offset:16384
  v_mfma_f32_16x16x32_bf16 v[120:123], v[52:55], v[176:179], v[120:123]
  ds_read_b64_tr_b16 v[42:43], v34 offset:16896
  v_mfma_f32_16x16x32_bf16 v[124:127], v[56:59], v[172:175], v[124:127]
  s_add_u32 m0, s44, 1024
  ds_read_b64_tr_b16 v[44:45], v35 offset:16384
  buffer_load_dwordx4 v3, s[8:11], s80 offen lds
  v_mfma_f32_16x16x32_bf16 v[128:131], v[56:59], v[176:179], v[128:131]
  ds_read_b64_tr_b16 v[46:47], v35 offset:16896
  s_waitcnt lgkmcnt(8)
  v_mfma_f32_16x16x32_bf16 v[224:227], v[60:63], v[244:247], v[224:227]
  ds_read_b64_tr_b16 v[48:49], v32 offset:20480
  ds_read_b64_tr_b16 v[50:51], v32 offset:20992
  s_waitcnt lgkmcnt(8)
  v_mfma_f32_16x16x32_bf16 v[132:135], v[64:67], v[188:191], v[132:135]
  s_add_u32 m0, s44, 2048
  ds_read_b64_tr_b16 v[52:53], v33 offset:20480
  buffer_load_dwordx4 v4, s[8:11], s80 offen lds
  v_mfma_f32_16x16x32_bf16 v[136:139], v[64:67], v[192:195], v[136:139]
  ds_read_b64_tr_b16 v[54:55], v33 offset:20992
  s_waitcnt vmcnt(6)
  ds_read_b128 v[204:207], v10 offset:4096
  s_waitcnt lgkmcnt(7)
  v_mfma_f32_16x16x32_bf16 v[140:143], v[36:39], v[188:191], v[140:143]
  ds_read_b64_tr_b16 v[56:57], v34 offset:20480
  v_mfma_f32_16x16x32_bf16 v[144:147], v[36:39], v[192:195], v[144:147]
  s_add_u32 m0, s44, 3072
  ds_read_b64_tr_b16 v[58:59], v34 offset:20992
  buffer_load_dwordx4 v5, s[8:11], s80 offen lds
  v_mfma_f32_16x16x32_bf16 v[148:151], v[40:43], v[188:191], v[148:151]
  ds_read_b64_tr_b16 v[60:61], v35 offset:20480
  ds_read_b64_tr_b16 v[62:63], v35 offset:20992
  ds_read_b128 v[208:211], v10 offset:6144
  s_waitcnt lgkmcnt(8)
  v_mfma_f32_16x16x32_bf16 v[152:155], v[44:47], v[188:191], v[152:155]
  s_barrier
  ds_read_b64_tr_b16 v[64:65], v12 offset:49152
  ds_read_b64_tr_b16 v[66:67], v12 offset:50176
  v_mfma_f32_16x16x32_bf16 v[132:135], v[48:51], v[196:199], v[132:135]
  s_add_u32 m0, s45, 81920
  ds_read_b64_tr_b16 v[36:37], v13 offset:49152
  buffer_load_dwordx4 v7, s[16:19], s83 offen lds
  v_mfma_f32_16x16x32_bf16 v[136:139], v[48:51], v[200:203], v[136:139]
  ds_read_b64_tr_b16 v[38:39], v13 offset:50176
  ds_read_b128 v[212:215], v11 offset:4096
  s_waitcnt lgkmcnt(8)
  v_mfma_f32_16x16x32_bf16 v[140:143], v[52:55], v[196:199], v[140:143]
  ds_read_b64_tr_b16 v[40:41], v14 offset:49152
  v_mfma_f32_16x16x32_bf16 v[144:147], v[52:55], v[200:203], v[144:147]
  s_add_u32 m0, s45, 40960
  ds_read_b64_tr_b16 v[42:43], v14 offset:50176
  buffer_load_dwordx4 v6, s[12:15], s78 offen lds
  v_mfma_f32_16x16x32_bf16 v[148:151], v[56:59], v[196:199], v[148:151]
  ds_read_b64_tr_b16 v[44:45], v15 offset:49152
  ds_read_b64_tr_b16 v[46:47], v15 offset:50176
  ds_read_b128 v[216:219], v11 offset:6144
  s_waitcnt lgkmcnt(8)
  v_mfma_f32_16x16x32_bf16 v[152:155], v[60:63], v[196:199], v[152:155]
  ds_read_b64_tr_b16 v[48:49], v16 offset:49152
  ds_read_b64_tr_b16 v[50:51], v16 offset:50176
  v_mfma_f32_16x16x32_bf16 v[68:71], v[64:67], v[180:183], v[68:71]
  ds_read_b64_tr_b16 v[52:53], v17 offset:49152
  v_mfma_f32_16x16x32_bf16 v[72:75], v[64:67], v[184:187], v[72:75]
  ds_read_b64_tr_b16 v[54:55], v17 offset:50176
  s_waitcnt lgkmcnt(7)
  v_mfma_f32_16x16x32_bf16 v[76:79], v[36:39], v[180:183], v[76:79]
  ds_read_b64_tr_b16 v[56:57], v18 offset:49152
  v_mfma_f32_16x16x32_bf16 v[80:83], v[36:39], v[184:187], v[80:83]
  ds_read_b64_tr_b16 v[58:59], v18 offset:50176
  v_mfma_f32_16x16x32_bf16 v[84:87], v[40:43], v[180:183], v[84:87]
  ds_read_b64_tr_b16 v[60:61], v19 offset:49152
  v_mfma_f32_16x16x32_bf16 v[88:91], v[40:43], v[184:187], v[88:91]
  ds_read_b64_tr_b16 v[62:63], v19 offset:50176
  s_waitcnt lgkmcnt(6)
  v_mfma_f32_16x16x32_bf16 v[92:95], v[44:47], v[180:183], v[92:95]
  ds_read_b64_tr_b16 v[64:65], v30 offset:49152
  v_mfma_f32_16x16x32_bf16 v[96:99], v[44:47], v[184:187], v[96:99]
  ds_read_b64_tr_b16 v[66:67], v30 offset:50176
  v_mfma_f32_16x16x32_bf16 v[100:103], v[48:51], v[180:183], v[100:103]
  ds_read_b64_tr_b16 v[36:37], v32 offset:0
  v_mfma_f32_16x16x32_bf16 v[104:107], v[48:51], v[184:187], v[104:107]
  ds_read_b64_tr_b16 v[38:39], v32 offset:512
  s_waitcnt lgkmcnt(6)
  v_mfma_f32_16x16x32_bf16 v[108:111], v[52:55], v[180:183], v[108:111]
  ds_read_b64_tr_b16 v[40:41], v33 offset:0
  v_mfma_f32_16x16x32_bf16 v[112:115], v[52:55], v[184:187], v[112:115]
  s_add_u32 m0, s44, 4096
  ds_read_b64_tr_b16 v[42:43], v33 offset:512
  buffer_load_dwordx4 v2, s[8:11], s84 offen lds
  v_mfma_f32_16x16x32_bf16 v[116:119], v[56:59], v[180:183], v[116:119]
  ds_read_b64_tr_b16 v[44:45], v34 offset:0
  v_mfma_f32_16x16x32_bf16 v[120:123], v[56:59], v[184:187], v[120:123]
  ds_read_b64_tr_b16 v[46:47], v34 offset:512
  s_waitcnt lgkmcnt(6)
  v_mfma_f32_16x16x32_bf16 v[124:127], v[60:63], v[180:183], v[124:127]
  s_add_u32 m0, s44, 5120
  ds_read_b64_tr_b16 v[48:49], v35 offset:0
  buffer_load_dwordx4 v3, s[8:11], s84 offen lds
  v_mfma_f32_16x16x32_bf16 v[128:131], v[60:63], v[184:187], v[128:131]
  ds_read_b64_tr_b16 v[50:51], v35 offset:512
  v_mfma_f32_16x16x32_bf16 v[224:227], v[64:67], v[244:247], v[224:227]
  ds_read_b64_tr_b16 v[52:53], v32 offset:4096
  ds_read_b64_tr_b16 v[54:55], v32 offset:4608
  s_waitcnt lgkmcnt(6)
  v_mfma_f32_16x16x32_bf16 v[132:135], v[36:39], v[204:207], v[132:135]
  s_add_u32 m0, s44, 6144
  ds_read_b64_tr_b16 v[56:57], v33 offset:4096
  buffer_load_dwordx4 v4, s[8:11], s84 offen lds
  s_waitcnt vmcnt(5)
  ds_read_b128 v[156:159], v10 offset:0
  v_mfma_f32_16x16x32_bf16 v[136:139], v[36:39], v[208:211], v[136:139]
  ds_read_b64_tr_b16 v[58:59], v33 offset:4608
  v_mfma_f32_16x16x32_bf16 v[140:143], v[40:43], v[204:207], v[140:143]
  ds_read_b64_tr_b16 v[60:61], v34 offset:4096
  v_mfma_f32_16x16x32_bf16 v[144:147], v[40:43], v[208:211], v[144:147]
  s_add_u32 m0, s44, 7168
  ds_read_b64_tr_b16 v[62:63], v34 offset:4608
  buffer_load_dwordx4 v5, s[8:11], s84 offen lds
  ds_read_b128 v[160:163], v10 offset:2048
  s_waitcnt lgkmcnt(8)
  v_mfma_f32_16x16x32_bf16 v[148:151], v[44:47], v[204:207], v[148:151]
  ds_read_b64_tr_b16 v[64:65], v35 offset:4096
  ds_read_b64_tr_b16 v[66:67], v35 offset:4608
  v_mfma_f32_16x16x32_bf16 v[152:155], v[48:51], v[204:207], v[152:155]
  s_waitcnt vmcnt(5)
  s_barrier
  ds_read_b64_tr_b16 v[36:37], v12 offset:57344
  ds_read_b64_tr_b16 v[38:39], v12 offset:58368
  s_waitcnt lgkmcnt(7)
  v_mfma_f32_16x16x32_bf16 v[132:135], v[52:55], v[212:215], v[132:135]
  s_add_u32 m0, s45, 90112
  ds_read_b64_tr_b16 v[40:41], v13 offset:57344
  buffer_load_dwordx4 v7, s[16:19], s87 offen lds
  ds_read_b128 v[164:167], v11 offset:0
  v_mfma_f32_16x16x32_bf16 v[136:139], v[52:55], v[216:219], v[136:139]
  ds_read_b64_tr_b16 v[42:43], v13 offset:58368
  v_mfma_f32_16x16x32_bf16 v[140:143], v[56:59], v[212:215], v[140:143]
  ds_read_b64_tr_b16 v[44:45], v14 offset:57344
  v_mfma_f32_16x16x32_bf16 v[144:147], v[56:59], v[216:219], v[144:147]
  s_add_u32 m0, s45, 49152
  ds_read_b64_tr_b16 v[46:47], v14 offset:58368
  buffer_load_dwordx4 v6, s[12:15], s81 offen lds
  ds_read_b128 v[168:171], v11 offset:2048
  s_waitcnt lgkmcnt(8)
  v_mfma_f32_16x16x32_bf16 v[148:151], v[60:63], v[212:215], v[148:151]
  ds_read_b64_tr_b16 v[48:49], v15 offset:57344
  ds_read_b64_tr_b16 v[50:51], v15 offset:58368
  v_mfma_f32_16x16x32_bf16 v[152:155], v[64:67], v[212:215], v[152:155]
  s_mov_b32 s96, 0
  ds_read_b64_tr_b16 v[52:53], v16 offset:57344
  ds_read_b64_tr_b16 v[54:55], v16 offset:58368
  s_waitcnt lgkmcnt(7)
  v_mfma_f32_16x16x32_bf16 v[68:71], v[36:39], v[188:191], v[68:71]
  ds_read_b64_tr_b16 v[56:57], v17 offset:57344
L_nchk:
  v_readfirstlane_b32 s97, v251
  s_add_u32 s96, s96, 2
  s_nop 0
  s_cmp_lg_u32 s97, 0
  s_cbranch_scc1 L_nok
  s_bitcmp1_b32 s96, 15
  s_cbranch_scc1 L_nok
  s_sleep 2
  global_load_dword v251, v28, s[42:43] sc0 sc1
  s_waitcnt vmcnt(0)
  s_branch L_nchk
L_nok:
  v_mfma_f32_16x16x32_bf16 v[72:75], v[36:39], v[192:195], v[72:75]
  v_cmp_eq_u32 vcc, 0, v1
  s_nop 1
  v_cndmask_b32 v249, -1, 0, vcc
  ds_read_b64_tr_b16 v[58:59], v17 offset:58368
  v_mfma_f32_16x16x32_bf16 v[76:79], v[40:43], v[188:191], v[76:79]
  ds_read_b64_tr_b16 v[60:61], v18 offset:57344
  buffer_store_dwordx2 v[250:251], v249, s[28:31], s3 offen sc1
  v_mfma_f32_16x16x32_bf16 v[80:83], v[40:43], v[192:195], v[80:83]
  v_cndmask_b32 v236, v224, v225, s[54:55]
  v_mov_b32 v237, s97
  ds_read_b64_tr_b16 v[62:63], v18 offset:58368
  s_waitcnt lgkmcnt(6)
  v_mfma_f32_16x16x32_bf16 v[84:87], v[44:47], v[188:191], v[84:87]
  v_cndmask_b32 v236, v236, v226, s[56:57]
  v_cndmask_b32 v236, v236, v227, s[58:59]
  ds_read_b64_tr_b16 v[64:65], v19 offset:57344
  v_mfma_f32_16x16x32_bf16 v[88:91], v[44:47], v[192:195], v[88:91]
  v_cvt_pk_bf16_f32 v240, v236, v236
  v_lshlrev_b32 v240, 16, v240
  ds_read_b64_tr_b16 v[66:67], v19 offset:58368
  v_mfma_f32_16x16x32_bf16 v[92:95], v[48:51], v[188:191], v[92:95]
  v_sub_f32 v240, v236, v240
  v_cvt_pk_bf16_f32 v236, v236, v240
  ds_read_b64_tr_b16 v[36:37], v32 offset:8192
  v_mfma_f32_16x16x32_bf16 v[96:99], v[48:51], v[192:195], v[96:99]
  ds_read_b64_tr_b16 v[38:39], v32 offset:8704
  buffer_store_dwordx2 v[236:237], v232, s[28:31], s40 offen sc1
  s_waitcnt lgkmcnt(6)
  v_mfma_f32_16x16x32_bf16 v[100:103], v[52:55], v[188:191], v[100:103]
  v_cndmask_b32 v238, v228, v229, s[54:55]
  v_mov_b32 v239, s97
  ds_read_b64_tr_b16 v[40:41], v33 offset:8192
  v_mfma_f32_16x16x32_bf16 v[104:107], v[52:55], v[192:195], v[104:107]
  v_cndmask_b32 v238, v238, v230, s[56:57]
  v_cndmask_b32 v238, v238, v231, s[58:59]
  ds_read_b64_tr_b16 v[42:43], v33 offset:8704
  v_mfma_f32_16x16x32_bf16 v[108:111], v[56:59], v[188:191], v[108:111]
  v_cvt_pk_bf16_f32 v240, v238, v238
  v_lshlrev_b32 v240, 16, v240
  s_add_u32 m0, s44, 0
  ds_read_b64_tr_b16 v[44:45], v34 offset:8192
  buffer_load_dwordx4 v2, s[8:11], s88 offen lds
  v_mfma_f32_16x16x32_bf16 v[112:115], v[56:59], v[192:195], v[112:115]
  v_sub_f32 v240, v238, v240
  v_cvt_pk_bf16_f32 v238, v238, v240
  ds_read_b64_tr_b16 v[46:47], v34 offset:8704
  s_waitcnt lgkmcnt(6)
  v_mfma_f32_16x16x32_bf16 v[116:119], v[60:63], v[188:191], v[116:119]
  ds_read_b64_tr_b16 v[48:49], v35 offset:8192
  v_mfma_f32_16x16x32_bf16 v[120:123], v[60:63], v[192:195], v[120:123]
  s_add_u32 m0, s44, 1024
  ds_read_b64_tr_b16 v[50:51], v35 offset:8704
  buffer_load_dwordx4 v3, s[8:11], s88 offen lds
  v_mfma_f32_16x16x32_bf16 v[124:127], v[64:67], v[188:191], v[124:127]
  s_barrier
  ds_read_b64_tr_b16 v[52:53], v12 offset:24576
  v_mfma_f32_16x16x32_bf16 v[128:131], v[64:67], v[192:195], v[128:131]
  ds_read_b64_tr_b16 v[54:55], v12 offset:25600
  s_waitcnt lgkmcnt(6)
  v_mfma_f32_16x16x32_bf16 v[132:135], v[36:39], v[156:159], v[132:135]
  s_add_u32 m0, s44, 2048
  ds_read_b64_tr_b16 v[56:57], v13 offset:24576
  buffer_load_dwordx4 v4, s[8:11], s88 offen lds
  v_mfma_f32_16x16x32_bf16 v[136:139], v[36:39], v[160:163], v[136:139]
  ds_read_b64_tr_b16 v[58:59], v13 offset:25600
  v_mfma_f32_16x16x32_bf16 v[140:143], v[40:43], v[156:159], v[140:143]
  ds_read_b64_tr_b16 v[60:61], v14 offset:24576
  v_mfma_f32_16x16x32_bf16 v[144:147], v[40:43], v[160:163], v[144:147]
  s_add_u32 m0, s44, 3072
  ds_read_b64_tr_b16 v[62:63], v14 offset:25600
  buffer_load_dwordx4 v5, s[8:11], s88 offen lds
  s_waitcnt lgkmcnt(6)
  v_mfma_f32_16x16x32_bf16 v[148:151], v[44:47], v[156:159], v[148:151]
  ds_read_b64_tr_b16 v[64:65], v15 offset:24576
  ds_read_b64_tr_b16 v[66:67], v15 offset:25600
  v_mfma_f32_16x16x32_bf16 v[152:155], v[48:51], v[156:159], v[152:155]
  ds_read_b64_tr_b16 v[36:37], v16 offset:24576
  ds_read_b64_tr_b16 v[38:39], v16 offset:25600
  s_waitcnt lgkmcnt(6)
  v_mfma_f32_16x16x32_bf16 v[68:71], v[52:55], v[196:199], v[68:71]
  s_add_u32 m0, s45, 73728
  ds_read_b64_tr_b16 v[40:41], v17 offset:24576
  buffer_load_dwordx4 v7, s[16:19], s91 offen lds
  v_mfma_f32_16x16x32_bf16 v[72:75], v[52:55], v[200:203], v[72:75]
  ds_read_b64_tr_b16 v[42:43], v17 offset:25600
  v_mfma_f32_16x16x32_bf16 v[76:79], v[56:59], v[196:199], v[76:79]
  ds_read_b64_tr_b16 v[44:45], v18 offset:24576
  s_waitcnt vmcnt(9)
  ds_read_b128 v[172:175], v10 offset:4096
  v_mfma_f32_16x16x32_bf16 v[80:83], v[56:59], v[200:203], v[80:83]
  ds_read_b64_tr_b16 v[46:47], v18 offset:25600
  buffer_store_dwordx2 v[238:239], v232, s[28:31], s41 offen sc1
  s_waitcnt lgkmcnt(7)
  v_mfma_f32_16x16x32_bf16 v[84:87], v[60:63], v[196:199], v[84:87]
  ds_read_b64_tr_b16 v[48:49], v19 offset:24576
  v_mfma_f32_16x16x32_bf16 v[88:91], v[60:63], v[200:203], v[88:91]
  ds_read_b64_tr_b16 v[50:51], v19 offset:25600
  ds_read_b128 v[176:179], v10 offset:6144
  v_mfma_f32_16x16x32_bf16 v[92:95], v[64:67], v[196:199], v[92:95]
  ds_read_b64_tr_b16 v[52:53], v32 offset:12288
  v_mfma_f32_16x16x32_bf16 v[96:99], v[64:67], v[200:203], v[96:99]
  ds_read_b64_tr_b16 v[54:55], v32 offset:12800
  s_waitcnt lgkmcnt(8)
  v_mfma_f32_16x16x32_bf16 v[100:103], v[36:39], v[196:199], v[100:103]
  ds_read_b64_tr_b16 v[56:57], v33 offset:12288
  ds_read_b128 v[180:183], v11 offset:4096
  v_mfma_f32_16x16x32_bf16 v[104:107], v[36:39], v[200:203], v[104:107]
  ds_read_b64_tr_b16 v[58:59], v33 offset:12800
  v_mfma_f32_16x16x32_bf16 v[108:111], v[40:43], v[196:199], v[108:111]
  ds_read_b64_tr_b16 v[60:61], v34 offset:12288
  v_mfma_f32_16x16x32_bf16 v[112:115], v[40:43], v[200:203], v[112:115]
  ds_read_b64_tr_b16 v[62:63], v34 offset:12800
  ds_read_b128 v[184:187], v11 offset:6144
  s_waitcnt lgkmcnt(9)
  v_mfma_f32_16x16x32_bf16 v[116:119], v[44:47], v[196:199], v[116:119]
  ds_read_b64_tr_b16 v[64:65], v35 offset:12288
  v_mfma_f32_16x16x32_bf16 v[120:123], v[44:47], v[200:203], v[120:123]
  ds_read_b64_tr_b16 v[66:67], v35 offset:12800
  v_mfma_f32_16x16x32_bf16 v[124:127], v[48:51], v[196:199], v[124:127]
  s_waitcnt vmcnt(9)
  s_barrier
  ds_read_b64_tr_b16 v[36:37], v12 offset:32768
  v_mfma_f32_16x16x32_bf16 v[128:131], v[48:51], v[200:203], v[128:131]
  s_add_u32 m0, s45, 57344
  ds_read_b64_tr_b16 v[38:39], v12 offset:33792
  buffer_load_dwordx4 v6, s[12:15], s82 offen lds
  s_waitcnt lgkmcnt(7)
  v_mfma_f32_16x16x32_bf16 v[132:135], v[52:55], v[164:167], v[132:135]
  ds_read_b64_tr_b16 v[40:41], v13 offset:32768
  v_mfma_f32_16x16x32_bf16 v[136:139], v[52:55], v[168:171], v[136:139]
  ds_read_b64_tr_b16 v[42:43], v13 offset:33792
  v_mfma_f32_16x16x32_bf16 v[140:143], v[56:59], v[164:167], v[140:143]
  ds_read_b64_tr_b16 v[44:45], v14 offset:32768
  v_mfma_f32_16x16x32_bf16 v[144:147], v[56:59], v[168:171], v[144:147]
  ds_read_b64_tr_b16 v[46:47], v14 offset:33792
  s_waitcnt lgkmcnt(6)
  v_mfma_f32_16x16x32_bf16 v[148:151], v[60:63], v[164:167], v[148:151]
  ds_read_b64_tr_b16 v[48:49], v15 offset:32768
  ds_read_b64_tr_b16 v[50:51], v15 offset:33792
  v_mfma_f32_16x16x32_bf16 v[152:155], v[64:67], v[164:167], v[152:155]
  ds_read_b64_tr_b16 v[52:53], v16 offset:32768
  ds_read_b64_tr_b16 v[54:55], v16 offset:33792
  s_waitcnt lgkmcnt(6)
  v_mfma_f32_16x16x32_bf16 v[68:71], v[36:39], v[204:207], v[68:71]
  ds_read_b64_tr_b16 v[56:57], v17 offset:32768
  v_mfma_f32_16x16x32_bf16 v[72:75], v[36:39], v[208:211], v[72:75]
  ds_read_b64_tr_b16 v[58:59], v17 offset:33792
  v_mfma_f32_16x16x32_bf16 v[76:79], v[40:43], v[204:207], v[76:79]
  s_add_u32 m0, s44, 4096
  ds_read_b64_tr_b16 v[60:61], v18 offset:32768
  buffer_load_dwordx4 v2, s[8:11], s92 offen lds
  v_mfma_f32_16x16x32_bf16 v[80:83], v[40:43], v[208:211], v[80:83]
  ds_read_b64_tr_b16 v[62:63], v18 offset:33792
  s_waitcnt lgkmcnt(6)
  v_mfma_f32_16x16x32_bf16 v[84:87], v[44:47], v[204:207], v[84:87]
  ds_read_b64_tr_b16 v[64:65], v19 offset:32768
  v_mfma_f32_16x16x32_bf16 v[88:91], v[44:47], v[208:211], v[88:91]
  s_add_u32 m0, s44, 5120
  ds_read_b64_tr_b16 v[66:67], v19 offset:33792
  buffer_load_dwordx4 v3, s[8:11], s92 offen lds
  v_mfma_f32_16x16x32_bf16 v[92:95], v[48:51], v[204:207], v[92:95]
  ds_read_b64_tr_b16 v[36:37], v32 offset:16384
  v_mfma_f32_16x16x32_bf16 v[96:99], v[48:51], v[208:211], v[96:99]
  ds_read_b64_tr_b16 v[38:39], v32 offset:16896
  s_waitcnt lgkmcnt(6)
  v_mfma_f32_16x16x32_bf16 v[100:103], v[52:55], v[204:207], v[100:103]
  s_add_u32 m0, s44, 6144
  ds_read_b64_tr_b16 v[40:41], v33 offset:16384
  buffer_load_dwordx4 v4, s[8:11], s92 offen lds
  v_mfma_f32_16x16x32_bf16 v[104:107], v[52:55], v[208:211], v[104:107]
  ds_read_b64_tr_b16 v[42:43], v33 offset:16896
  v_mfma_f32_16x16x32_bf16 v[108:111], v[56:59], v[204:207], v[108:111]
  ds_read_b64_tr_b16 v[44:45], v34 offset:16384
  v_mfma_f32_16x16x32_bf16 v[112:115], v[56:59], v[208:211], v[112:115]
  s_add_u32 m0, s44, 7168
  ds_read_b64_tr_b16 v[46:47], v34 offset:16896
  buffer_load_dwordx4 v5, s[8:11], s92 offen lds
  s_waitcnt lgkmcnt(6)
  v_mfma_f32_16x16x32_bf16 v[116:119], v[60:63], v[204:207], v[116:119]
  ds_read_b64_tr_b16 v[48:49], v35 offset:16384
  v_mfma_f32_16x16x32_bf16 v[120:123], v[60:63], v[208:211], v[120:123]
  ds_read_b64_tr_b16 v[50:51], v35 offset:16896
  v_mfma_f32_16x16x32_bf16 v[124:127], v[64:67], v[204:207], v[124:127]
  s_barrier
  ds_read_b64_tr_b16 v[52:53], v12 offset:40960
  v_mfma_f32_16x16x32_bf16 v[128:131], v[64:67], v[208:211], v[128:131]
  s_add_u32 m0, s45, 24576
  ds_read_b64_tr_b16 v[54:55], v12 offset:41984
  buffer_load_dwordx4 v6, s[12:15], s85 offen lds
  s_waitcnt lgkmcnt(6)
  v_mfma_f32_16x16x32_bf16 v[132:135], v[36:39], v[172:175], v[132:135]
  ds_read_b64_tr_b16 v[56:57], v13 offset:40960
  v_mfma_f32_16x16x32_bf16 v[136:139], v[36:39], v[176:179], v[136:139]
  ds_read_b64_tr_b16 v[58:59], v13 offset:41984
  v_mfma_f32_16x16x32_bf16 v[140:143], v[40:43], v[172:175], v[140:143]
  s_add_u32 m0, s45, 81920
  ds_read_b64_tr_b16 v[60:61], v14 offset:40960
  buffer_load_dwordx4 v7, s[16:19], s95 offen lds
  v_mfma_f32_16x16x32_bf16 v[144:147], v[40:43], v[176:179], v[144:147]
  ds_read_b64_tr_b16 v[62:63], v14 offset:41984
  s_waitcnt lgkmcnt(6)
  v_mfma_f32_16x16x32_bf16 v[148:151], v[44:47], v[172:175], v[148:151]
  ds_read_b64_tr_b16 v[64:65], v15 offset:40960
  ds_read_b64_tr_b16 v[66:67], v15 offset:41984
  v_mfma_f32_16x16x32_bf16 v[152:155], v[48:51], v[172:175], v[152:155]
  ds_read_b64_tr_b16 v[36:37], v16 offset:40960
  ds_read_b64_tr_b16 v[38:39], v16 offset:41984
  s_waitcnt lgkmcnt(6)
  v_mfma_f32_16x16x32_bf16 v[68:71], v[52:55], v[212:215], v[68:71]
  ds_read_b64_tr_b16 v[40:41], v17 offset:40960
  v_mfma_f32_16x16x32_bf16 v[72:75], v[52:55], v[216:219], v[72:75]
  ds_read_b64_tr_b16 v[42:43], v17 offset:41984
  v_mfma_f32_16x16x32_bf16 v[76:79], v[56:59], v[212:215], v[76:79]
  ds_read_b64_tr_b16 v[44:45], v18 offset:40960
  s_waitcnt vmcnt(9)
  ds_read_b128 v[188:191], v10 offset:0
  v_mfma_f32_16x16x32_bf16 v[80:83], v[56:59], v[216:219], v[80:83]
  ds_read_b64_tr_b16 v[46:47], v18 offset:41984
  s_waitcnt lgkmcnt(7)
  v_mfma_f32_16x16x32_bf16 v[84:87], v[60:63], v[212:215], v[84:87]
  ds_read_b64_tr_b16 v[48:49], v19 offset:40960
  v_mfma_f32_16x16x32_bf16 v[88:91], v[60:63], v[216:219], v[88:91]
  ds_read_b64_tr_b16 v[50:51], v19 offset:41984
  ds_read_b128 v[192:195], v10 offset:2048
  v_mfma_f32_16x16x32_bf16 v[92:95], v[64:67], v[212:215], v[92:95]
  ds_read_b64_tr_b16 v[52:53], v32 offset:20480
  v_mfma_f32_16x16x32_bf16 v[96:99], v[64:67], v[216:219], v[96:99]
  ds_read_b64_tr_b16 v[54:55], v32 offset:20992
  s_waitcnt lgkmcnt(8)
  v_mfma_f32_16x16x32_bf16 v[100:103], v[36:39], v[212:215], v[100:103]
  ds_read_b64_tr_b16 v[56:57], v33 offset:20480
  ds_read_b128 v[196:199], v11 offset:0
  v_mfma_f32_16x16x32_bf16 v[104:107], v[36:39], v[216:219], v[104:107]
  ds_read_b64_tr_b16 v[58:59], v33 offset:20992
  v_mfma_f32_16x16x32_bf16 v[108:111], v[40:43], v[212:215], v[108:111]
  ds_read_b64_tr_b16 v[60:61], v34 offset:20480
  v_mfma_f32_16x16x32_bf16 v[112:115], v[40:43], v[216:219], v[112:115]
  ds_read_b64_tr_b16 v[62:63], v34 offset:20992
  ds_read_b128 v[200:203], v11 offset:2048
  s_waitcnt lgkmcnt(9)
  v_mfma_f32_16x16x32_bf16 v[116:119], v[44:47], v[212:215], v[116:119]
  ds_read_b64_tr_b16 v[64:65], v35 offset:20480
  v_mfma_f32_16x16x32_bf16 v[120:123], v[44:47], v[216:219], v[120:123]
  ds_read_b64_tr_b16 v[66:67], v35 offset:20992
  v_mfma_f32_16x16x32_bf16 v[124:127], v[48:51], v[212:215], v[124:127]
  s_waitcnt vmcnt(8)
  s_barrier
  ds_read_b64_tr_b16 v[36:37], v12 offset:49152
  v_mfma_f32_16x16x32_bf16 v[128:131], v[48:51], v[216:219], v[128:131]
  s_add_u32 m0, s45, 32768
  ds_read_b64_tr_b16 v[38:39], v12 offset:50176
  buffer_load_dwordx4 v6, s[12:15], s86 offen lds
  s_waitcnt lgkmcnt(7)
  v_mfma_f32_16x16x32_bf16 v[132:135], v[52:55], v[180:183], v[132:135]
  ds_read_b64_tr_b16 v[40:41], v13 offset:49152
  v_mfma_f32_16x16x32_bf16 v[136:139], v[52:55], v[184:187], v[136:139]
  ds_read_b64_tr_b16 v[42:43], v13 offset:50176
  v_mfma_f32_16x16x32_bf16 v[140:143], v[56:59], v[180:183], v[140:143]
  ds_read_b64_tr_b16 v[44:45], v14 offset:49152
  v_mfma_f32_16x16x32_bf16 v[144:147], v[56:59], v[184:187], v[144:147]
  ds_read_b64_tr_b16 v[46:47], v14 offset:50176
  s_waitcnt lgkmcnt(6)
  v_mfma_f32_16x16x32_bf16 v[148:151], v[60:63], v[180:183], v[148:151]
  ds_read_b64_tr_b16 v[48:49], v15 offset:49152
  ds_read_b64_tr_b16 v[50:51], v15 offset:50176
  v_mfma_f32_16x16x32_bf16 v[152:155], v[64:67], v[180:183], v[152:155]
  ds_read_b64_tr_b16 v[52:53], v16 offset:49152
  ds_read_b64_tr_b16 v[54:55], v16 offset:50176
  s_waitcnt lgkmcnt(6)
  v_mfma_f32_16x16x32_bf16 v[68:71], v[36:39], v[156:159], v[68:71]
  ds_read_b64_tr_b16 v[56:57], v17 offset:49152
  v_mfma_f32_16x16x32_bf16 v[72:75], v[36:39], v[160:163], v[72:75]
  ds_read_b64_tr_b16 v[58:59], v17 offset:50176
  buffer_load_dwordx2 v[236:237], v253, s[28:31], s32 offen offset:0 sc1
  v_mfma_f32_16x16x32_bf16 v[76:79], v[40:43], v[156:159], v[76:79]
  ds_read_b64_tr_b16 v[60:61], v18 offset:49152
  v_mfma_f32_16x16x32_bf16 v[80:83], v[40:43], v[160:163], v[80:83]
  ds_read_b64_tr_b16 v[62:63], v18 offset:50176
  s_waitcnt lgkmcnt(6)
  v_mfma_f32_16x16x32_bf16 v[84:87], v[44:47], v[156:159], v[84:87]
  ds_read_b64_tr_b16 v[64:65], v19 offset:49152
  buffer_load_dwordx2 v[238:239], v253, s[28:31], s32 offen offset:512 sc1
  v_mfma_f32_16x16x32_bf16 v[88:91], v[44:47], v[160:163], v[88:91]
  ds_read_b64_tr_b16 v[66:67], v19 offset:50176
  v_mfma_f32_16x16x32_bf16 v[92:95], v[48:51], v[156:159], v[92:95]
  ds_read_b64_tr_b16 v[36:37], v32 offset:0
  v_mfma_f32_16x16x32_bf16 v[96:99], v[48:51], v[160:163], v[96:99]
  ds_read_b64_tr_b16 v[38:39], v32 offset:512
  buffer_load_dwordx2 v[240:241], v253, s[28:31], s32 offen offset:1024 sc1
  s_waitcnt lgkmcnt(6)
  v_mfma_f32_16x16x32_bf16 v[100:103], v[52:55], v[156:159], v[100:103]
  ds_read_b64_tr_b16 v[40:41], v33 offset:0
  v_mfma_f32_16x16x32_bf16 v[104:107], v[52:55], v[160:163], v[104:107]
  ds_read_b64_tr_b16 v[42:43], v33 offset:512
  v_mfma_f32_16x16x32_bf16 v[108:111], v[56:59], v[156:159], v[108:111]
  ds_read_b64_tr_b16 v[44:45], v34 offset:0
  buffer_load_dwordx2 v[248:249], v233, s[28:31], s35 offen sc1
  v_mfma_f32_16x16x32_bf16 v[112:115], v[56:59], v[160:163], v[112:115]
  ds_read_b64_tr_b16 v[46:47], v34 offset:512
  s_waitcnt lgkmcnt(6)
  v_mfma_f32_16x16x32_bf16 v[116:119], v[60:63], v[156:159], v[116:119]
  ds_read_b64_tr_b16 v[48:49], v35 offset:0
  v_mfma_f32_16x16x32_bf16 v[120:123], v[60:63], v[160:163], v[120:123]
  ds_read_b64_tr_b16 v[50:51], v35 offset:512
  v_mfma_f32_16x16x32_bf16 v[124:127], v[64:67], v[156:159], v[124:127]
  s_waitcnt vmcnt(11)
  s_barrier
  ds_read_b64_tr_b16 v[52:53], v12 offset:57344
  v_mfma_f32_16x16x32_bf16 v[128:131], v[64:67], v[160:163], v[128:131]
  s_add_u32 m0, s45, 40960
  ds_read_b64_tr_b16 v[54:55], v12 offset:58368
  buffer_load_dwordx4 v6, s[12:15], s89 offen lds
  s_waitcnt lgkmcnt(6)
  v_mfma_f32_16x16x32_bf16 v[132:135], v[36:39], v[188:191], v[132:135]
  ds_read_b64_tr_b16 v[56:57], v13 offset:57344
  v_mfma_f32_16x16x32_bf16 v[136:139], v[36:39], v[192:195], v[136:139]
  ds_read_b64_tr_b16 v[58:59], v13 offset:58368
  v_mfma_f32_16x16x32_bf16 v[140:143], v[40:43], v[188:191], v[140:143]
  ds_read_b64_tr_b16 v[60:61], v14 offset:57344
  buffer_load_dwordx2 v[250:251], v233, s[28:31], s51 offen sc1
  v_mfma_f32_16x16x32_bf16 v[144:147], v[40:43], v[192:195], v[144:147]
  ds_read_b64_tr_b16 v[62:63], v14 offset:58368
  s_waitcnt lgkmcnt(6)
  v_mfma_f32_16x16x32_bf16 v[148:151], v[44:47], v[188:191], v[148:151]
  ds_read_b64_tr_b16 v[64:65], v15 offset:57344
  ds_read_b64_tr_b16 v[66:67], v15 offset:58368
  v_mfma_f32_16x16x32_bf16 v[152:155], v[48:51], v[188:191], v[152:155]
  ds_read_b64_tr_b16 v[36:37], v16 offset:57344
  ds_read_b64_tr_b16 v[38:39], v16 offset:58368
  s_waitcnt lgkmcnt(6)
  v_mfma_f32_16x16x32_bf16 v[68:71], v[52:55], v[164:167], v[68:71]
  ds_read_b64_tr_b16 v[40:41], v17 offset:57344
  v_mfma_f32_16x16x32_bf16 v[72:75], v[52:55], v[168:171], v[72:75]
  ds_read_b64_tr_b16 v[42:43], v17 offset:58368
  v_mfma_f32_16x16x32_bf16 v[76:79], v[56:59], v[164:167], v[76:79]
  ds_read_b64_tr_b16 v[44:45], v18 offset:57344
  s_waitcnt vmcnt(9)
  ds_read_b128 v[204:207], v10 offset:4096
  v_mfma_f32_16x16x32_bf16 v[80:83], v[56:59], v[168:171], v[80:83]
  ds_read_b64_tr_b16 v[46:47], v18 offset:58368
  s_waitcnt lgkmcnt(7)
  v_mfma_f32_16x16x32_bf16 v[84:87], v[60:63], v[164:167], v[84:87]
  ds_read_b64_tr_b16 v[48:49], v19 offset:57344
  v_mfma_f32_16x16x32_bf16 v[88:91], v[60:63], v[168:171], v[88:91]
  ds_read_b64_tr_b16 v[50:51], v19 offset:58368
  ds_read_b128 v[208:211], v10 offset:6144
  v_mfma_f32_16x16x32_bf16 v[92:95], v[64:67], v[164:167], v[92:95]
  ds_read_b64_tr_b16 v[52:53], v32 offset:4096
  v_mfma_f32_16x16x32_bf16 v[96:99], v[64:67], v[168:171], v[96:99]
  ds_read_b64_tr_b16 v[54:55], v32 offset:4608
  s_waitcnt lgkmcnt(8)
  v_mfma_f32_16x16x32_bf16 v[100:103], v[36:39], v[164:167], v[100:103]
  ds_read_b64_tr_b16 v[56:57], v33 offset:4096
  ds_read_b128 v[212:215], v11 offset:4096
  v_mfma_f32_16x16x32_bf16 v[104:107], v[36:39], v[168:171], v[104:107]
  ds_read_b64_tr_b16 v[58:59], v33 offset:4608
  v_mfma_f32_16x16x32_bf16 v[108:111], v[40:43], v[164:167], v[108:111]
  ds_read_b64_tr_b16 v[60:61], v34 offset:4096
  v_mfma_f32_16x16x32_bf16 v[112:115], v[40:43], v[168:171], v[112:115]
  ds_read_b64_tr_b16 v[62:63], v34 offset:4608
  ds_read_b128 v[216:219], v11 offset:6144
  s_waitcnt lgkmcnt(9)
  v_mfma_f32_16x16x32_bf16 v[116:119], v[44:47], v[164:167], v[116:119]
  ds_read_b64_tr_b16 v[64:65], v35 offset:4096
  v_mfma_f32_16x16x32_bf16 v[120:123], v[44:47], v[168:171], v[120:123]
  ds_read_b64_tr_b16 v[66:67], v35 offset:4608
  v_mfma_f32_16x16x32_bf16 v[124:127], v[48:51], v[164:167], v[124:127]
  s_waitcnt vmcnt(7)
  s_barrier
  ds_read_b64_tr_b16 v[36:37], v12 offset:24576
  v_mfma_f32_16x16x32_bf16 v[128:131], v[48:51], v[168:171], v[128:131]
  s_add_u32 m0, s45, 49152
  ds_read_b64_tr_b16 v[38:39], v12 offset:25600
  buffer_load_dwordx4 v6, s[12:15], s90 offen lds
  s_waitcnt lgkmcnt(7)
  v_mfma_f32_16x16x32_bf16 v[132:135], v[52:55], v[196:199], v[132:135]
  ds_read_b64_tr_b16 v[40:41], v13 offset:24576
  v_mfma_f32_16x16x32_bf16 v[136:139], v[52:55], v[200:203], v[136:139]
  ds_read_b64_tr_b16 v[42:43], v13 offset:25600
  v_mfma_f32_16x16x32_bf16 v[140:143], v[56:59], v[196:199], v[140:143]
  ds_read_b64_tr_b16 v[44:45], v14 offset:24576
  v_mfma_f32_16x16x32_bf16 v[144:147], v[56:59], v[200:203], v[144:147]
  ds_read_b64_tr_b16 v[46:47], v14 offset:25600
  s_waitcnt lgkmcnt(6)
  v_mfma_f32_16x16x32_bf16 v[148:151], v[60:63], v[196:199], v[148:151]
  ds_read_b64_tr_b16 v[48:49], v15 offset:24576
  ds_read_b64_tr_b16 v[50:51], v15 offset:25600
  v_mfma_f32_16x16x32_bf16 v[152:155], v[64:67], v[196:199], v[152:155]
  ds_read_b64_tr_b16 v[52:53], v16 offset:24576
  ds_read_b64_tr_b16 v[54:55], v16 offset:25600
  s_waitcnt lgkmcnt(6)
  v_mfma_f32_16x16x32_bf16 v[68:71], v[36:39], v[172:175], v[68:71]
  ds_read_b64_tr_b16 v[56:57], v17 offset:24576
  s_waitcnt vmcnt(1)
  v_mfma_f32_16x16x32_bf16 v[72:75], v[36:39], v[176:179], v[72:75]
  v_min3_u32 v30, v237, v239, v241
  v_max3_u32 v31, v237, v239, v241
  ds_read_b64_tr_b16 v[58:59], v17 offset:25600
  v_mfma_f32_16x16x32_bf16 v[76:79], v[40:43], v[172:175], v[76:79]
  v_min3_u32 v30, v30, v249, v251
  v_max3_u32 v31, v31, v249, v251
  ds_read_b64_tr_b16 v[60:61], v18 offset:24576
  v_mfma_f32_16x16x32_bf16 v[80:83], v[40:43], v[176:179], v[80:83]
  v_min_u32 v30, s97, v30
  v_max_u32 v31, s97, v31
  ds_read_b64_tr_b16 v[62:63], v18 offset:25600
  s_waitcnt lgkmcnt(6)
  v_mfma_f32_16x16x32_bf16 v[84:87], v[44:47], v[172:175], v[84:87]
  v_cmp_ne_u32 vcc, v30, v31
  ds_read_b64_tr_b16 v[64:65], v19 offset:24576
  v_mfma_f32_16x16x32_bf16 v[88:91], v[44:47], v[176:179], v[88:91]
  ds_read_b64_tr_b16 v[66:67], v19 offset:25600
  s_mov_b32 s96, 0
  s_cbranch_vccz L_cok
L_cretry:
  s_sleep 2
  buffer_load_dwordx2 v[236:237], v253, s[28:31], s32 offen offset:0 sc1
  buffer_load_dwordx2 v[238:239], v253, s[28:31], s32 offen offset:512 sc1
  buffer_load_dwordx2 v[240:241], v253, s[28:31], s32 offen offset:1024 sc1
  buffer_load_dwordx2 v[248:249], v233, s[28:31], s35 offen sc1
  buffer_load_dwordx2 v[250:251], v233, s[28:31], s51 offen sc1
  s_add_u32 s96, s96, 1
  s_waitcnt vmcnt(0)
  v_min3_u32 v30, v237, v239, v241
  v_max3_u32 v31, v237, v239, v241
  v_min3_u32 v30, v30, v249, v251
  v_max3_u32 v31, v31, v249, v251
  v_min_u32 v30, s97, v30
  v_max_u32 v31, s97, v31
  v_cmp_ne_u32 vcc, v30, v31
  s_bitcmp1_b32 s96, 14
  s_cbranch_scc1 L_cok
  s_cbranch_vccnz L_cretry
L_cok:
  v_mfma_f32_16x16x32_bf16 v[92:95], v[48:51], v[172:175], v[92:95]
  v_and_b32 v220, 0xffff, v248
  v_lshrrev_b32 v222, 16, v248
  ds_read_b64_tr_b16 v[36:37], v32 offset:8192
  v_mfma_f32_16x16x32_bf16 v[96:99], v[48:51], v[176:179], v[96:99]
  v_xor_b32 v220, 0x8000, v220
  v_and_b32 v248, 0xffff0000, v248
  ds_read_b64_tr_b16 v[38:39], v32 offset:8704
  s_waitcnt lgkmcnt(6)
  v_mfma_f32_16x16x32_bf16 v[100:103], v[52:55], v[172:175], v[100:103]
  v_rcp_f32 v228, v248
  ds_read_b64_tr_b16 v[40:41], v33 offset:8192
  v_mfma_f32_16x16x32_bf16 v[104:107], v[52:55], v[176:179], v[104:107]
  v_lshl_or_b32 v220, v220, 16, v220
  v_mov_b32 v223, 0
  ds_read_b64_tr_b16 v[42:43], v33 offset:8704
  v_mfma_f32_16x16x32_bf16 v[108:111], v[56:59], v[172:175], v[108:111]
  v_mov_b32 v221, v220
  v_mul_f32 v230, 0x3e0293ee, v228
  ds_read_b64_tr_b16 v[44:45], v34 offset:8192
  v_mfma_f32_16x16x32_bf16 v[112:115], v[56:59], v[176:179], v[112:115]
  v_and_b32 v224, 0xffff, v250
  v_lshrrev_b32 v226, 16, v250
  ds_read_b64_tr_b16 v[46:47], v34 offset:8704
  s_waitcnt lgkmcnt(6)
  v_mfma_f32_16x16x32_bf16 v[116:119], v[60:63], v[172:175], v[116:119]
  v_xor_b32 v224, 0x8000, v224
  v_and_b32 v250, 0xffff0000, v250
  ds_read_b64_tr_b16 v[48:49], v35 offset:8192
  v_mfma_f32_16x16x32_bf16 v[120:123], v[60:63], v[176:179], v[120:123]
  v_rcp_f32 v229, v250
  ds_read_b64_tr_b16 v[50:51], v35 offset:8704
  v_mfma_f32_16x16x32_bf16 v[124:127], v[64:67], v[172:175], v[124:127]
  s_barrier
  v_lshl_or_b32 v224, v224, 16, v224
  v_mov_b32 v227, 0
  ds_read_b64_tr_b16 v[52:53], v12 offset:32768
  v_mfma_f32_16x16x32_bf16 v[128:131], v[64:67], v[176:179], v[128:131]
  v_mov_b32 v225, v224
  v_mul_f32 v231, 0x3e0293ee, v229
  s_add_u32 m0, s45, 57344
  ds_read_b64_tr_b16 v[54:55], v12 offset:33792
  buffer_load_dwordx4 v6, s[12:15], s93 offen lds
  s_waitcnt lgkmcnt(6)
  v_mfma_f32_16x16x32_bf16 v[132:135], v[36:39], v[204:207], v[132:135]
  ds_read_b64_tr_b16 v[56:57], v13 offset:32768
  ds_write2_b32 v234, v236, v28 offset0:0 offset1:2
  v_add_u32 v234, 4096, v234
  v_mfma_f32_16x16x32_bf16 v[136:139], v[36:39], v[208:211], v[136:139]
  ds_read_b64_tr_b16 v[58:59], v13 offset:33792
  v_mfma_f32_16x16x32_bf16 v[140:143], v[40:43], v[204:207], v[140:143]
  ds_read_b64_tr_b16 v[60:61], v14 offset:32768
  ds_write2_b32 v234, v238, v28 offset0:0 offset1:2
  v_add_u32 v234, 4096, v234
  v_mfma_f32_16x16x32_bf16 v[144:147], v[40:43], v[208:211], v[144:147]
  ds_read_b64_tr_b16 v[62:63], v14 offset:33792
  s_waitcnt lgkmcnt(8)
  v_mfma_f32_16x16x32_bf16 v[148:151], v[44:47], v[204:207], v[148:151]
  ds_read_b64_tr_b16 v[64:65], v15 offset:32768
  ds_read_b64_tr_b16 v[66:67], v15 offset:33792
  ds_write2_b32 v234, v240, v252 offset0:0 offset1:2
  v_mfma_f32_16x16x32_bf16 v[152:155], v[48:51], v[204:207], v[152:155]
  ds_read_b64_tr_b16 v[36:37], v16 offset:32768
  ds_read_b64_tr_b16 v[38:39], v16 offset:33792
  s_waitcnt lgkmcnt(8)
  v_mfma_f32_16x16x32_bf16 v[68:71], v[52:55], v[180:183], v[68:71]
  ds_read_b64_tr_b16 v[40:41], v17 offset:32768
  v_mfma_f32_16x16x32_bf16 v[72:75], v[52:55], v[184:187], v[72:75]
  ds_read_b64_tr_b16 v[42:43], v17 offset:33792
  v_mfma_f32_16x16x32_bf16 v[76:79], v[56:59], v[180:183], v[76:79]
  ds_read_b64_tr_b16 v[44:45], v18 offset:32768
  v_mfma_f32_16x16x32_bf16 v[80:83], v[56:59], v[184:187], v[80:83]
  ds_read_b64_tr_b16 v[46:47], v18 offset:33792
  s_waitcnt lgkmcnt(7)
  v_mfma_f32_16x16x32_bf16 v[84:87], v[60:63], v[180:183], v[84:87]
  ds_read_b64_tr_b16 v[48:49], v19 offset:32768
  v_mfma_f32_16x16x32_bf16 v[88:91], v[60:63], v[184:187], v[88:91]
  ds_read_b64_tr_b16 v[50:51], v19 offset:33792
  v_mfma_f32_16x16x32_bf16 v[92:95], v[64:67], v[180:183], v[92:95]
  ds_read_b64_tr_b16 v[52:53], v32 offset:12288
  v_mfma_f32_16x16x32_bf16 v[96:99], v[64:67], v[184:187], v[96:99]
  ds_read_b64_tr_b16 v[54:55], v32 offset:12800
  s_waitcnt lgkmcnt(6)
  v_mfma_f32_16x16x32_bf16 v[100:103], v[36:39], v[180:183], v[100:103]
  ds_read_b64_tr_b16 v[56:57], v33 offset:12288
  v_mfma_f32_16x16x32_bf16 v[104:107], v[36:39], v[184:187], v[104:107]
  ds_read_b64_tr_b16 v[58:59], v33 offset:12800
  v_mfma_f32_16x16x32_bf16 v[108:111], v[40:43], v[180:183], v[108:111]
  ds_read_b64_tr_b16 v[60:61], v34 offset:12288
  v_mfma_f32_16x16x32_bf16 v[112:115], v[40:43], v[184:187], v[112:115]
  ds_read_b64_tr_b16 v[62:63], v34 offset:12800
  s_waitcnt lgkmcnt(6)
  v_mfma_f32_16x16x32_bf16 v[116:119], v[44:47], v[180:183], v[116:119]
  ds_read_b64_tr_b16 v[64:65], v35 offset:12288
  v_mfma_f32_16x16x32_bf16 v[120:123], v[44:47], v[184:187], v[120:123]
  ds_read_b64_tr_b16 v[66:67], v35 offset:12800
  v_mfma_f32_16x16x32_bf16 v[124:127], v[48:51], v[180:183], v[124:127]
  v_mfma_f32_16x16x32_bf16 v[128:131], v[48:51], v[184:187], v[128:131]
  s_barrier
  ds_read_b128 v[36:39], v235 offset:8192
  s_waitcnt lgkmcnt(5)
  v_mfma_f32_16x16x32_bf16 v[132:135], v[52:55], v[212:215], v[132:135]
  s_add_u32 m0, s45, 24576
  s_nop 0
  buffer_load_dwordx4 v6, s[12:15], s94 offen lds
  v_mfma_f32_16x16x32_bf16 v[136:139], v[52:55], v[216:219], v[136:139]
  ds_read_b128 v[40:43], v235 offset:9216
  v_mfma_f32_16x16x32_bf16 v[140:143], v[56:59], v[212:215], v[140:143]
  v_mfma_f32_16x16x32_bf16 v[144:147], v[56:59], v[216:219], v[144:147]
  s_add_u32 s62, s46, 0
  s_add_u32 m0, s45, 0
  ds_read_b128 v[44:47], v235 offset:10240
  buffer_load_dwordx4 v8, s[20:23], s62 offen lds
  s_waitcnt lgkmcnt(3)
  v_mfma_f32_16x16x32_bf16 v[148:151], v[60:63], v[212:215], v[148:151]
  ds_read_b128 v[48:51], v235 offset:11264
  v_mfma_f32_16x16x32_bf16 v[152:155], v[64:67], v[212:215], v[152:155]
  ds_read_b64_tr_b16 v[52:53], v12 offset:40960
  ds_read_b64_tr_b16 v[54:55], v12 offset:41984
  s_waitcnt lgkmcnt(4)
  v_mfma_f32_16x16x32_bf16 v[132:135], v[36:39], v[220:223], v[132:135]
  s_add_u32 s62, s46, 8192
  s_add_u32 m0, s45, 8192
  ds_read_b64_tr_b16 v[56:57], v13 offset:40960
  buffer_load_dwordx4 v8, s[20:23], s62 offen lds
  v_mfma_f32_16x16x32_bf16 v[136:139], v[36:39], v[224:227], v[136:139]
  ds_read_b64_tr_b16 v[58:59], v13 offset:41984
  v_mfma_f32_16x16x32_bf16 v[140:143], v[40:43], v[220:223], v[140:143]
  ds_read_b64_tr_b16 v[60:61], v14 offset:40960
  v_mfma_f32_16x16x32_bf16 v[144:147], v[40:43], v[224:227], v[144:147]
  s_add_u32 s62, s46, 0
  s_add_u32 m0, s45, 65536
  ds_read_b64_tr_b16 v[62:63], v14 offset:41984
  buffer_load_dwordx4 v9, s[24:27], s62 offen lds
  s_waitcnt lgkmcnt(6)
  v_mfma_f32_16x16x32_bf16 v[148:151], v[44:47], v[220:223], v[148:151]
  v_max_f32 v132, 0, v132
  v_max_f32 v133, 0, v133
  ds_read_b64_tr_b16 v[64:65], v15 offset:40960
  ds_read_b64_tr_b16 v[66:67], v15 offset:41984
  v_mfma_f32_16x16x32_bf16 v[152:155], v[48:51], v[220:223], v[152:155]
  v_max_f32 v134, 0, v134
  v_max_f32 v135, 0, v135
  ds_read_b64_tr_b16 v[36:37], v16 offset:40960
  ds_read_b64_tr_b16 v[38:39], v16 offset:41984
  s_waitcnt lgkmcnt(6)
  v_mfma_f32_16x16x32_bf16 v[68:71], v[52:55], v[188:191], v[68:71]
  v_mul_f32 v132, v228, v132
  v_mul_f32 v133, v228, v133
  s_add_u32 s62, s46, 16384
  s_add_u32 m0, s45, 16384
  ds_read_b64_tr_b16 v[40:41], v17 offset:40960
  buffer_load_dwordx4 v8, s[20:23], s62 offen lds
  v_mfma_f32_16x16x32_bf16 v[72:75], v[52:55], v[192:195], v[72:75]
  v_mul_f32 v134, v228, v134
  v_mul_f32 v135, v228, v135
  ds_read_b64_tr_b16 v[42:43], v17 offset:41984
  v_mfma_f32_16x16x32_bf16 v[76:79], v[56:59], v[188:191], v[76:79]
  v_mul_f32 v132, v132, v132
  v_mul_f32 v133, v133, v133
  ds_read_b64_tr_b16 v[44:45], v18 offset:40960
  v_mfma_f32_16x16x32_bf16 v[80:83], v[56:59], v[192:195], v[80:83]
  v_mul_f32 v134, v134, v134
  v_mul_f32 v135, v135, v135
  ds_read_b64_tr_b16 v[46:47], v18 offset:41984
  s_waitcnt lgkmcnt(6)
  v_mfma_f32_16x16x32_bf16 v[84:87], v[60:63], v[188:191], v[84:87]
  v_cvt_pk_bf16_f32 v236, v132, v133
  v_cvt_pk_bf16_f32 v237, v134, v135
  ds_read_b64_tr_b16 v[48:49], v19 offset:40960
  v_mfma_f32_16x16x32_bf16 v[88:91], v[60:63], v[192:195], v[88:91]
  v_max_f32 v136, 0, v136
  v_max_f32 v137, 0, v137
  ds_read_b64_tr_b16 v[50:51], v19 offset:41984
  v_mfma_f32_16x16x32_bf16 v[92:95], v[64:67], v[188:191], v[92:95]
  s_waitcnt vmcnt(4)
  s_barrier
  v_max_f32 v138, 0, v138
  v_max_f32 v139, 0, v139
  ds_read_b64_tr_b16 v[52:53], v12 offset:49152
  v_mfma_f32_16x16x32_bf16 v[96:99], v[64:67], v[192:195], v[96:99]
  v_mul_f32 v136, v229, v136
  v_mul_f32 v137, v229, v137
  ds_read_b64_tr_b16 v[54:55], v12 offset:50176
  s_waitcnt lgkmcnt(6)
  v_mfma_f32_16x16x32_bf16 v[100:103], v[36:39], v[188:191], v[100:103]
  v_mul_f32 v138, v229, v138
  v_mul_f32 v139, v229, v139
  ds_read_b64_tr_b16 v[56:57], v13 offset:49152
  v_mfma_f32_16x16x32_bf16 v[104:107], v[36:39], v[192:195], v[104:107]
  v_mul_f32 v136, v136, v136
  v_mul_f32 v137, v137, v137
  ds_read_b64_tr_b16 v[58:59], v13 offset:50176
  v_mfma_f32_16x16x32_bf16 v[108:111], v[40:43], v[188:191], v[108:111]
  v_mul_f32 v138, v138, v138
  v_mul_f32 v139, v139, v139
  ds_read_b64_tr_b16 v[60:61], v12 offset:57344
  v_mfma_f32_16x16x32_bf16 v[112:115], v[40:43], v[192:195], v[112:115]
  v_cvt_pk_bf16_f32 v240, v136, v137
  v_cvt_pk_bf16_f32 v241, v138, v139
  ds_read_b64_tr_b16 v[62:63], v12 offset:58368
  s_waitcnt lgkmcnt(6)
  v_mfma_f32_16x16x32_bf16 v[116:119], v[44:47], v[188:191], v[116:119]
  v_max_f32 v140, 0, v140
  v_max_f32 v141, 0, v141
  ds_read_b64_tr_b16 v[64:65], v13 offset:57344
  v_mfma_f32_16x16x32_bf16 v[120:123], v[44:47], v[192:195], v[120:123]
  v_max_f32 v142, 0, v142
  v_max_f32 v143, 0, v143
  ds_read_b64_tr_b16 v[66:67], v13 offset:58368
  v_mfma_f32_16x16x32_bf16 v[124:127], v[48:51], v[188:191], v[124:127]
  v_mul_f32 v140, v228, v140
  v_mul_f32 v141, v228, v141
  ds_read_b64_tr_b16 v[36:37], v12 offset:24576
  v_mfma_f32_16x16x32_bf16 v[128:131], v[48:51], v[192:195], v[128:131]
  v_mul_f32 v142, v228, v142
  v_mul_f32 v143, v228, v143
  ds_read_b64_tr_b16 v[38:39], v12 offset:25600
  s_waitcnt lgkmcnt(6)
  v_mfma_f32_16x16x32_bf16 v[68:71], v[52:55], v[196:199], v[68:71]
  v_mul_f32 v140, v140, v140
  v_mul_f32 v141, v141, v141
  ds_read_b64_tr_b16 v[40:41], v13 offset:24576
  v_mfma_f32_16x16x32_bf16 v[72:75], v[52:55], v[200:203], v[72:75]
  v_mul_f32 v142, v142, v142
  v_mul_f32 v143, v143, v143
  ds_read_b64_tr_b16 v[42:43], v13 offset:25600
  v_mfma_f32_16x16x32_bf16 v[76:79], v[56:59], v[196:199], v[76:79]
  v_cvt_pk_bf16_f32 v238, v140, v141
  v_cvt_pk_bf16_f32 v239, v142, v143
  v_mfma_f32_16x16x32_bf16 v[80:83], v[56:59], v[200:203], v[80:83]
  v_max_f32 v144, 0, v144
  v_max_f32 v145, 0, v145
  ds_read_b128 v[44:47], v235 offset:0
  s_waitcnt lgkmcnt(5)
  v_mfma_f32_16x16x32_bf16 v[68:71], v[60:63], v[204:207], v[68:71]
  v_max_f32 v146, 0, v146
  v_max_f32 v147, 0, v147
  v_mfma_f32_16x16x32_bf16 v[72:75], v[60:63], v[208:211], v[72:75]
  v_mul_f32 v144, v229, v144
  v_mul_f32 v145, v229, v145
  ds_read_b128 v[48:51], v235 offset:1024
  v_mfma_f32_16x16x32_bf16 v[76:79], v[64:67], v[204:207], v[76:79]
  v_mul_f32 v146, v229, v146
  v_mul_f32 v147, v229, v147
  ds_read_b64_tr_b16 v[52:53], v14 offset:49152
  v_mfma_f32_16x16x32_bf16 v[80:83], v[64:67], v[208:211], v[80:83]
  v_mul_f32 v144, v144, v144
  v_mul_f32 v145, v145, v145
  ds_read_b64_tr_b16 v[54:55], v14 offset:50176
  s_waitcnt lgkmcnt(4)
  v_mfma_f32_16x16x32_bf16 v[68:71], v[36:39], v[212:215], v[68:71]
  v_mul_f32 v146, v146, v146
  v_mul_f32 v147, v147, v147
  ds_read_b64_tr_b16 v[56:57], v15 offset:49152
  v_mfma_f32_16x16x32_bf16 v[72:75], v[36:39], v[216:219], v[72:75]
  v_cvt_pk_bf16_f32 v242, v144, v145
  v_cvt_pk_bf16_f32 v243, v146, v147
  ds_read_b64_tr_b16 v[58:59], v15 offset:50176
  v_mfma_f32_16x16x32_bf16 v[76:79], v[40:43], v[212:215], v[76:79]
  v_max_f32 v148, 0, v148
  v_max_f32 v149, 0, v149
  ds_read_b64_tr_b16 v[60:61], v14 offset:57344
  v_mfma_f32_16x16x32_bf16 v[80:83], v[40:43], v[216:219], v[80:83]
  v_max_f32 v150, 0, v150
  v_max_f32 v151, 0, v151
  ds_read_b64_tr_b16 v[62:63], v14 offset:58368
  s_waitcnt lgkmcnt(6)
  v_mfma_f32_16x16x32_bf16 v[68:71], v[44:47], v[220:223], v[68:71]
  v_mul_f32 v148, v228, v148
  v_mul_f32 v149, v228, v149
  ds_read_b64_tr_b16 v[64:65], v15 offset:57344
  v_mfma_f32_16x16x32_bf16 v[72:75], v[44:47], v[224:227], v[72:75]
  v_mul_f32 v150, v228, v150
  v_mul_f32 v151, v228, v151
  ds_read_b64_tr_b16 v[66:67], v15 offset:58368
  v_mfma_f32_16x16x32_bf16 v[76:79], v[48:51], v[220:223], v[76:79]
  v_mul_f32 v148, v148, v148
  v_mul_f32 v149, v149, v149
  ds_read_b64_tr_b16 v[36:37], v14 offset:24576
  v_mfma_f32_16x16x32_bf16 v[80:83], v[48:51], v[224:227], v[80:83]
  v_mul_f32 v150, v150, v150
  v_mul_f32 v151, v151, v151
  ds_read_b64_tr_b16 v[38:39], v14 offset:25600
  s_waitcnt lgkmcnt(6)
  v_mfma_f32_16x16x32_bf16 v[84:87], v[52:55], v[196:199], v[84:87]
  v_cvt_pk_bf16_f32 v244, v148, v149
  v_cvt_pk_bf16_f32 v245, v150, v151
  ds_read_b64_tr_b16 v[40:41], v15 offset:24576
  v_mfma_f32_16x16x32_bf16 v[88:91], v[52:55], v[200:203], v[88:91]
  ds_read_b64_tr_b16 v[42:43], v15 offset:25600
  v_mfma_f32_16x16x32_bf16 v[92:95], v[56:59], v[196:199], v[92:95]
  v_mul_f32 v68, v230, v68
  v_mul_f32 v69, v230, v69
  v_mfma_f32_16x16x32_bf16 v[96:99], v[56:59], v[200:203], v[96:99]
  v_mul_f32 v70, v230, v70
  v_mul_f32 v71, v230, v71
  ds_read_b128 v[44:47], v235 offset:2048
  s_waitcnt lgkmcnt(5)
  v_mfma_f32_16x16x32_bf16 v[84:87], v[60:63], v[204:207], v[84:87]
  v_cvt_pk_bf16_f32 v156, v68, v69
  v_cvt_pk_bf16_f32 v157, v70, v71
  v_mfma_f32_16x16x32_bf16 v[88:91], v[60:63], v[208:211], v[88:91]
  v_mul_f32 v76, v230, v76
  v_mul_f32 v77, v230, v77
  ds_read_b128 v[48:51], v235 offset:3072
  v_mfma_f32_16x16x32_bf16 v[92:95], v[64:67], v[204:207], v[92:95]
  v_mul_f32 v78, v230, v78
  v_mul_f32 v79, v230, v79
  ds_read_b64_tr_b16 v[52:53], v16 offset:49152
  v_mfma_f32_16x16x32_bf16 v[96:99], v[64:67], v[208:211], v[96:99]
  v_cvt_pk_bf16_f32 v158, v76, v77
  v_cvt_pk_bf16_f32 v159, v78, v79
  ds_read_b64_tr_b16 v[54:55], v16 offset:50176
  s_waitcnt lgkmcnt(4)
  v_mfma_f32_16x16x32_bf16 v[84:87], v[36:39], v[212:215], v[84:87]
  v_mul_f32 v72, v231, v72
  v_mul_f32 v73, v231, v73
  ds_read_b64_tr_b16 v[56:57], v17 offset:49152
  v_mfma_f32_16x16x32_bf16 v[88:91], v[36:39], v[216:219], v[88:91]
  v_mul_f32 v74, v231, v74
  v_mul_f32 v75, v231, v75
  ds_read_b64_tr_b16 v[58:59], v17 offset:50176
  v_mfma_f32_16x16x32_bf16 v[92:95], v[40:43], v[212:215], v[92:95]
  v_cvt_pk_bf16_f32 v172, v72, v73
  v_cvt_pk_bf16_f32 v173, v74, v75
  ds_read_b64_tr_b16 v[60:61], v16 offset:57344
  v_mfma_f32_16x16x32_bf16 v[96:99], v[40:43], v[216:219], v[96:99]
  v_mul_f32 v80, v231, v80
  v_mul_f32 v81, v231, v81
  ds_read_b64_tr_b16 v[62:63], v16 offset:58368
  s_waitcnt lgkmcnt(6)
  v_mfma_f32_16x16x32_bf16 v[84:87], v[44:47], v[220:223], v[84:87]
  v_mul_f32 v82, v231, v82
  v_mul_f32 v83, v231, v83
  ds_read_b64_tr_b16 v[64:65], v17 offset:57344
  v_mfma_f32_16x16x32_bf16 v[88:91], v[44:47], v[224:227], v[88:91]
  v_cvt_pk_bf16_f32 v174, v80, v81
  v_cvt_pk_bf16_f32 v175, v82, v83
  ds_read_b64_tr_b16 v[66:67], v17 offset:58368
  v_mfma_f32_16x16x32_bf16 v[92:95], v[48:51], v[220:223], v[92:95]
  v_permlane32_swap_b32 v156, v158
  ds_read_b64_tr_b16 v[36:37], v16 offset:24576
  v_mfma_f32_16x16x32_bf16 v[96:99], v[48:51], v[224:227], v[96:99]
  v_permlane32_swap_b32 v157, v159
  ds_read_b64_tr_b16 v[38:39], v16 offset:25600
  s_waitcnt lgkmcnt(6)
  v_mfma_f32_16x16x32_bf16 v[100:103], v[52:55], v[196:199], v[100:103]
  v_permlane32_swap_b32 v172, v174
  ds_read_b64_tr_b16 v[40:41], v17 offset:24576
  v_mfma_f32_16x16x32_bf16 v[104:107], v[52:55], v[200:203], v[104:107]
  v_permlane32_swap_b32 v173, v175
  ds_read_b64_tr_b16 v[42:43], v17 offset:25600
  v_mfma_f32_16x16x32_bf16 v[108:111], v[56:59], v[196:199], v[108:111]
  v_permlane16_swap_b32 v156, v158
  v_mfma_f32_16x16x32_bf16 v[112:115], v[56:59], v[200:203], v[112:115]
  v_permlane16_swap_b32 v157, v159
  ds_read_b128 v[44:47], v235 offset:4096
  s_waitcnt lgkmcnt(5)
  v_mfma_f32_16x16x32_bf16 v[100:103], v[60:63], v[204:207], v[100:103]
  v_permlane16_swap_b32 v172, v174
  v_mfma_f32_16x16x32_bf16 v[104:107], v[60:63], v[208:211], v[104:107]
  v_permlane16_swap_b32 v173, v175
  ds_read_b128 v[48:51], v235 offset:5120
  v_mfma_f32_16x16x32_bf16 v[108:111], v[64:67], v[204:207], v[108:111]
  v_mul_f32 v84, v230, v84
  v_mul_f32 v85, v230, v85
  ds_read_b64_tr_b16 v[52:53], v18 offset:49152
  v_mfma_f32_16x16x32_bf16 v[112:115], v[64:67], v[208:211], v[112:115]
  v_mul_f32 v86, v230, v86
  v_mul_f32 v87, v230, v87
  ds_read_b64_tr_b16 v[54:55], v18 offset:50176
  s_waitcnt lgkmcnt(4)
  v_mfma_f32_16x16x32_bf16 v[100:103], v[36:39], v[212:215], v[100:103]
  v_cvt_pk_bf16_f32 v160, v84, v85
  v_cvt_pk_bf16_f32 v161, v86, v87
  ds_read_b64_tr_b16 v[56:57], v19 offset:49152
  v_mfma_f32_16x16x32_bf16 v[104:107], v[36:39], v[216:219], v[104:107]
  v_mul_f32 v92, v230, v92
  v_mul_f32 v93, v230, v93
  ds_read_b64_tr_b16 v[58:59], v19 offset:50176
  v_mfma_f32_16x16x32_bf16 v[108:111], v[40:43], v[212:215], v[108:111]
  v_mul_f32 v94, v230, v94
  v_mul_f32 v95, v230, v95
  ds_read_b64_tr_b16 v[60:61], v18 offset:57344
  v_mfma_f32_16x16x32_bf16 v[112:115], v[40:43], v[216:219], v[112:115]
  v_cvt_pk_bf16_f32 v162, v92, v93
  v_cvt_pk_bf16_f32 v163, v94, v95
  ds_read_b64_tr_b16 v[62:63], v18 offset:58368
  s_waitcnt lgkmcnt(6)
  v_mfma_f32_16x16x32_bf16 v[100:103], v[44:47], v[220:223], v[100:103]
  v_mul_f32 v88, v231, v88
  v_mul_f32 v89, v231, v89
  ds_read_b64_tr_b16 v[64:65], v19 offset:57344
  v_mfma_f32_16x16x32_bf16 v[104:107], v[44:47], v[224:227], v[104:107]
  v_mul_f32 v90, v231, v90
  v_mul_f32 v91, v231, v91
  ds_read_b64_tr_b16 v[66:67], v19 offset:58368
  v_mfma_f32_16x16x32_bf16 v[108:111], v[48:51], v[220:223], v[108:111]
  v_cvt_pk_bf16_f32 v176, v88, v89
  v_cvt_pk_bf16_f32 v177, v90, v91
  ds_read_b64_tr_b16 v[36:37], v18 offset:24576
  v_mfma_f32_16x16x32_bf16 v[112:115], v[48:51], v[224:227], v[112:115]
  v_mul_f32 v96, v231, v96
  v_mul_f32 v97, v231, v97
  ds_read_b64_tr_b16 v[38:39], v18 offset:25600
  s_waitcnt lgkmcnt(6)
  v_mfma_f32_16x16x32_bf16 v[116:119], v[52:55], v[196:199], v[116:119]
  v_mul_f32 v98, v231, v98
  v_mul_f32 v99, v231, v99
  ds_read_b64_tr_b16 v[40:41], v19 offset:24576
  v_mfma_f32_16x16x32_bf16 v[120:123], v[52:55], v[200:203], v[120:123]
  v_cvt_pk_bf16_f32 v178, v96, v97
  v_cvt_pk_bf16_f32 v179, v98, v99
  ds_read_b64_tr_b16 v[42:43], v19 offset:25600
  v_mfma_f32_16x16x32_bf16 v[124:127], v[56:59], v[196:199], v[124:127]
  v_permlane32_swap_b32 v160, v162
  v_mfma_f32_16x16x32_bf16 v[128:131], v[56:59], v[200:203], v[128:131]
  v_permlane32_swap_b32 v161, v163
  ds_read_b128 v[44:47], v235 offset:6144
  s_waitcnt lgkmcnt(5)
  v_mfma_f32_16x16x32_bf16 v[116:119], v[60:63], v[204:207], v[116:119]
  v_permlane32_swap_b32 v176, v178
  v_mfma_f32_16x16x32_bf16 v[120:123], v[60:63], v[208:211], v[120:123]
  v_permlane32_swap_b32 v177, v179
  ds_read_b128 v[48:51], v235 offset:7168
  v_mfma_f32_16x16x32_bf16 v[124:127], v[64:67], v[204:207], v[124:127]
  v_permlane16_swap_b32 v160, v162
  v_mfma_f32_16x16x32_bf16 v[128:131], v[64:67], v[208:211], v[128:131]
  v_permlane16_swap_b32 v161, v163
  s_waitcnt lgkmcnt(2)
  v_mfma_f32_16x16x32_bf16 v[116:119], v[36:39], v[212:215], v[116:119]
  v_permlane16_swap_b32 v176, v178
  v_mfma_f32_16x16x32_bf16 v[120:123], v[36:39], v[216:219], v[120:123]
  v_permlane16_swap_b32 v177, v179
  v_mfma_f32_16x16x32_bf16 v[124:127], v[40:43], v[212:215], v[124:127]
  v_mul_f32 v100, v230, v100
  v_mul_f32 v101, v230, v101
  v_mfma_f32_16x16x32_bf16 v[128:131], v[40:43], v[216:219], v[128:131]
  v_mul_f32 v102, v230, v102
  v_mul_f32 v103, v230, v103
  s_waitcnt lgkmcnt(0)
  v_mfma_f32_16x16x32_bf16 v[116:119], v[44:47], v[220:223], v[116:119]
  v_cvt_pk_bf16_f32 v164, v100, v101
  v_cvt_pk_bf16_f32 v165, v102, v103
  v_mfma_f32_16x16x32_bf16 v[120:123], v[44:47], v[224:227], v[120:123]
  v_mul_f32 v108, v230, v108
  v_mul_f32 v109, v230, v109
  v_mfma_f32_16x16x32_bf16 v[124:127], v[48:51], v[220:223], v[124:127]
  v_mul_f32 v110, v230, v110
  v_mul_f32 v111, v230, v111
  v_mfma_f32_16x16x32_bf16 v[128:131], v[48:51], v[224:227], v[128:131]
  v_cvt_pk_bf16_f32 v166, v108, v109
  v_cvt_pk_bf16_f32 v167, v110, v111
  s_load_dwordx2 s[94:95], s[0:1], 72
  v_mul_f32 v104, v231, v104
  v_mul_f32 v105, v231, v105
  v_mul_f32 v106, v231, v106
  v_mul_f32 v107, v231, v107
  v_cvt_pk_bf16_f32 v180, v104, v105
  v_cvt_pk_bf16_f32 v181, v106, v107
  v_mul_f32 v112, v231, v112
  v_mul_f32 v113, v231, v113
  v_mul_f32 v114, v231, v114
  v_mul_f32 v115, v231, v115
  v_cvt_pk_bf16_f32 v182, v112, v113
  v_cvt_pk_bf16_f32 v183, v114, v115
  v_permlane32_swap_b32 v164, v166
  v_permlane32_swap_b32 v165, v167
  v_permlane32_swap_b32 v180, v182
  v_permlane32_swap_b32 v181, v183
  v_permlane16_swap_b32 v164, v166
  v_permlane16_swap_b32 v165, v167
  v_permlane16_swap_b32 v180, v182
  v_permlane16_swap_b32 v181, v183
  v_mul_f32 v116, v230, v116
  v_mul_f32 v117, v230, v117
  v_mul_f32 v118, v230, v118
  v_mul_f32 v119, v230, v119
  v_cvt_pk_bf16_f32 v168, v116, v117
  v_cvt_pk_bf16_f32 v169, v118, v119
  v_mul_f32 v124, v230, v124
  v_mul_f32 v125, v230, v125
  v_mul_f32 v126, v230, v126
  v_mul_f32 v127, v230, v127
  v_cvt_pk_bf16_f32 v170, v124, v125
  v_cvt_pk_bf16_f32 v171, v126, v127
  v_mul_f32 v120, v231, v120
  v_mul_f32 v121, v231, v121
  v_mul_f32 v122, v231, v122
  v_mul_f32 v123, v231, v123
  v_cvt_pk_bf16_f32 v184, v120, v121
  v_cvt_pk_bf16_f32 v185, v122, v123
  v_mul_f32 v128, v231, v128
  v_mul_f32 v129, v231, v129
  v_mul_f32 v130, v231, v130
  v_mul_f32 v131, v231, v131
  v_cvt_pk_bf16_f32 v186, v128, v129
  v_cvt_pk_bf16_f32 v187, v130, v131
  v_permlane32_swap_b32 v168, v170
  v_permlane32_swap_b32 v169, v171
  v_permlane32_swap_b32 v184, v186
  v_permlane32_swap_b32 v185, v187
  v_permlane16_swap_b32 v168, v170
  v_permlane16_swap_b32 v169, v171
  v_permlane16_swap_b32 v184, v186
  v_permlane16_swap_b32 v185, v187
  v_add_u32 v12, v26, v12
  v_add_u32 v13, v26, v13
  v_add_u32 v14, v26, v14
  v_add_u32 v15, v26, v15
  v_add_u32 v16, v26, v16
  v_add_u32 v17, v26, v17
  v_add_u32 v18, v26, v18
  v_add_u32 v19, v26, v19
  s_waitcnt vmcnt(2)
  s_waitcnt lgkmcnt(0)
  s_barrier
  ds_read_b128 v[36:39], v20 offset:0
  ds_read_b128 v[40:43], v21 offset:0
  ds_read_b128 v[44:47], v22 offset:0
  ds_read_b128 v[48:51], v23 offset:0
  ds_read_b128 v[52:55], v20 offset:4096
  ds_read_b128 v[56:59], v21 offset:4096
  s_waitcnt lgkmcnt(4)
  v_mfma_f32_16x16x32_bf16 v[188:191], v[36:39], v[156:159], 0
  v_max_f32 v152, 0, v152
  v_max_f32 v153, 0, v153
  v_mfma_f32_16x16x32_bf16 v[196:199], v[36:39], v[172:175], 0
  v_max_f32 v154, 0, v154
  v_max_f32 v155, 0, v155
  s_add_u32 s62, s46, 24576
  s_add_u32 m0, s45, 24576
  ds_read_b128 v[60:63], v22 offset:4096
  buffer_load_dwordx4 v8, s[20:23], s62 offen lds
  v_mfma_f32_16x16x32_bf16 v[188:191], v[40:43], v[160:163], v[188:191]
  v_mul_f32 v152, v228, v152
  v_mul_f32 v153, v228, v153
  v_mfma_f32_16x16x32_bf16 v[196:199], v[40:43], v[176:179], v[196:199]
  v_mul_f32 v154, v228, v154
  v_mul_f32 v155, v228, v155
  s_add_u32 s62, s46, 8192
  s_add_u32 m0, s45, 73728
  ds_read_b128 v[64:67], v23 offset:4096
  buffer_load_dwordx4 v9, s[24:27], s62 offen lds
  s_waitcnt lgkmcnt(4)
  v_mfma_f32_16x16x32_bf16 v[188:191], v[44:47], v[164:167], v[188:191]
  v_mul_f32 v152, v152, v152
  v_mul_f32 v153, v153, v153
  v_mfma_f32_16x16x32_bf16 v[196:199], v[44:47], v[180:183], v[196:199]
  v_mul_f32 v154, v154, v154
  v_mul_f32 v155, v155, v155
  s_add_u32 s62, s46, 32768
  s_add_u32 m0, s45, 32768
  ds_read_b128 v[36:39], v20 offset:8192
  buffer_load_dwordx4 v8, s[20:23], s62 offen lds
  v_mfma_f32_16x16x32_bf16 v[188:191], v[48:51], v[168:171], v[188:191]
  v_cvt_pk_bf16_f32 v246, v152, v153
  v_cvt_pk_bf16_f32 v247, v154, v155
  v_mfma_f32_16x16x32_bf16 v[196:199], v[48:51], v[184:187], v[196:199]
  s_and_b32 s84, s2, 7
  s_lshr_b32 s85, s84, 1
  s_and_b32 s84, s84, 1
  s_add_u32 s62, s46, 16384
  s_add_u32 m0, s45, 81920
  ds_read_b128 v[40:43], v21 offset:8192
  buffer_load_dwordx4 v9, s[24:27], s62 offen lds
  s_waitcnt lgkmcnt(4)
  v_mfma_f32_16x16x32_bf16 v[192:195], v[52:55], v[156:159], 0
  s_lshl_b32 s84, s84, 3
  s_lshr_b32 s86, s2, 5
  s_add_u32 s84, s84, s86
  v_mfma_f32_16x16x32_bf16 v[200:203], v[52:55], v[172:175], 0
  s_bfe_u32 s86, s2, 0x20003
  s_mul_i32 s89, s85, 1409024
  s_mov_b32 s14, 4194304
  s_add_u32 s62, s46, 40960
  s_add_u32 m0, s45, 40960
  ds_read_b128 v[44:47], v22 offset:8192
  buffer_load_dwordx4 v8, s[20:23], s62 offen lds
  v_mfma_f32_16x16x32_bf16 v[192:195], v[56:59], v[160:163], v[192:195]
  s_cmp_eq_u32 s85, 3
  s_cselect_b32 s12, s6, s4
  s_cselect_b32 s13, s7, s5
  s_cselect_b32 s14, 1409024, s14
  s_cselect_b32 s89, 0, s89
  s_mov_b32 s15, 0x20000
  s_lshr_b32 s43, s2, 3
  v_mfma_f32_16x16x32_bf16 v[200:203], v[56:59], v[176:179], v[200:203]
  s_mul_i32 s43, s43, 44032
  s_add_u32 s43, s43, s89
  s_lshl_b32 s42, s84, 2
  s_add_u32 s62, s46, 24576
  s_add_u32 m0, s45, 90112
  ds_read_b128 v[48:51], v23 offset:8192
  buffer_load_dwordx4 v9, s[24:27], s62 offen lds
  s_waitcnt lgkmcnt(4)
  v_mfma_f32_16x16x32_bf16 v[192:195], v[60:63], v[164:167], v[192:195]
  s_add_u32 s42, s42, s86
  s_lshl_b32 s83, s42, 2
  s_add_u32 s42, s83, s85
  v_mfma_f32_16x16x32_bf16 v[200:203], v[60:63], v[180:183], v[200:203]
  s_lshl_b32 s42, s42, 15
  s_add_u32 s71, s42, 33554432
  s_add_u32 s71, s71, s45
  ds_read_b128 v[52:55], v20 offset:12288
  v_mfma_f32_16x16x32_bf16 v[192:195], v[64:67], v[168:171], v[192:195]
  s_add_u32 s79, s71, 8192
  s_add_u32 s80, s71, 16384
  s_add_u32 s81, s71, 24576
  v_mfma_f32_16x16x32_bf16 v[200:203], v[64:67], v[184:187], v[200:203]
  s_cmp_eq_u32 s85, 0
  s_cselect_b32 s78, 0x40000000, s71
  s_cmp_eq_u32 s85, 1
  s_cselect_b32 s79, 0x40000000, s79
  s_cmp_eq_u32 s85, 2
  s_cselect_b32 s80, 0x40000000, s80
  ds_read_b128 v[56:59], v21 offset:12288
  s_waitcnt lgkmcnt(4)
  v_mfma_f32_16x16x32_bf16 v[204:207], v[36:39], v[156:159], 0
  s_cmp_eq_u32 s85, 3
  s_cselect_b32 s81, 0x40000000, s81
  s_lshl_b32 s77, s38, 5
  s_add_u32 s77, s77, s37
  s_lshl_b32 s77, s77, 6
  s_add_u32 s77, s77, 48300032
  v_mov_b32 v10, s97
  v_mov_b32 v11, 0
  v_and_b32 v2, 0xff, v9
  v_lshrrev_b32 v3, 8, v9
  v_lshl_add_u32 v2, v3, 10, v2
  s_lshl_b32 s60, s86, 8
  v_add_u32 v2, s60, v2
  v_lshlrev_b32 v253, 7, v1
  v_add_u32 v253, s45, v253
  v_cmp_gt_u32 vcc, 8, v1
  s_nop 1
  v_cndmask_b32 v253, -1, v253, vcc
  v_mov_b32 v248, -1
  v_mov_b32 v249, -1
  v_mov_b32 v250, -1
  v_mov_b32 v251, -1
  v_mfma_f32_16x16x32_bf16 v[212:215], v[36:39], v[172:175], 0
  ds_read_b128 v[60:63], v22 offset:12288
  v_mfma_f32_16x16x32_bf16 v[204:207], v[40:43], v[160:163], v[204:207]
  v_exp_f32 v188, v188
  v_exp_f32 v189, v189
  v_mov_b32 v148, v188
  v_mfma_f32_16x16x32_bf16 v[212:215], v[40:43], v[176:179], v[212:215]
  v_exp_f32 v190, v190
  v_mov_b32 v149, v189
  v_cvt_pk_bf16_f32 v132, v188, v189
  s_add_u32 s62, s46, 49152
  s_add_u32 m0, s45, 49152
  ds_read_b128 v[64:67], v23 offset:12288
  buffer_load_dwordx4 v8, s[20:23], s62 offen lds
  s_waitcnt lgkmcnt(4)
  v_mfma_f32_16x16x32_bf16 v[204:207], v[44:47], v[164:167], v[204:207]
  v_exp_f32 v191, v191
  v_add_f32 v148, v148, v190
  v_exp_f32 v192, v192
  v_mfma_f32_16x16x32_bf16 v[212:215], v[44:47], v[180:183], v[212:215]
  s_waitcnt vmcnt(5)
  s_barrier
  v_add_f32 v149, v149, v191
  v_cvt_pk_bf16_f32 v133, v190, v191
  v_exp_f32 v193, v193
  ds_read_b128 v[36:39], v20 offset:16384
  v_mfma_f32_16x16x32_bf16 v[204:207], v[48:51], v[168:171], v[204:207]
  v_add_f32 v148, v148, v192
  v_exp_f32 v194, v194
  v_add_f32 v149, v149, v193
  v_mfma_f32_16x16x32_bf16 v[212:215], v[48:51], v[184:187], v[212:215]
  v_cvt_pk_bf16_f32 v134, v192, v193
  v_exp_f32 v195, v195
  v_add_f32 v148, v148, v194
  ds_read_b128 v[40:43], v21 offset:16384
  s_waitcnt lgkmcnt(4)
  v_mfma_f32_16x16x32_bf16 v[208:211], v[52:55], v[156:159], 0
  v_exp_f32 v196, v196
  v_add_f32 v149, v149, v195
  v_cvt_pk_bf16_f32 v135, v194, v195
  v_mfma_f32_16x16x32_bf16 v[216:219], v[52:55], v[172:175], 0
  v_exp_f32 v197, v197
  v_mov_b32 v150, v196
  v_exp_f32 v198, v198
  s_add_u32 s62, s46, 32768
  s_add_u32 m0, s45, 98304
  ds_read_b128 v[44:47], v22 offset:16384
  buffer_load_dwordx4 v9, s[24:27], s62 offen lds
  v_mfma_f32_16x16x32_bf16 v[208:211], v[56:59], v[160:163], v[208:211]
  v_mov_b32 v151, v197
  v_cvt_pk_bf16_f32 v136, v196, v197
  v_exp_f32 v199, v199
  v_mfma_f32_16x16x32_bf16 v[216:219], v[56:59], v[176:179], v[216:219]
  v_add_f32 v150, v150, v198
  v_exp_f32 v200, v200
  v_add_f32 v151, v151, v199
  ds_read_b128 v[48:51], v23 offset:16384
  s_waitcnt lgkmcnt(4)
  v_mfma_f32_16x16x32_bf16 v[208:211], v[60:63], v[164:167], v[208:211]
  v_cvt_pk_bf16_f32 v137, v198, v199
  v_exp_f32 v201, v201
  v_add_f32 v150, v150, v200
  v_mfma_f32_16x16x32_bf16 v[216:219], v[60:63], v[180:183], v[216:219]
  v_exp_f32 v202, v202
  v_add_f32 v151, v151, v201
  v_cvt_pk_bf16_f32 v138, v200, v201
  ds_read_b128 v[52:55], v20 offset:20480
  v_mfma_f32_16x16x32_bf16 v[208:211], v[64:67], v[168:171], v[208:211]
  v_exp_f32 v203, v203
  v_add_f32 v150, v150, v202
  v_add_f32 v151, v151, v203
  v_mfma_f32_16x16x32_bf16 v[216:219], v[64:67], v[184:187], v[216:219]
  v_cvt_pk_bf16_f32 v139, v202, v203
  ds_read_b128 v[56:59], v21 offset:20480
  s_waitcnt lgkmcnt(4)
  v_mfma_f32_16x16x32_bf16 v[188:191], v[36:39], v[156:159], 0
  v_exp_f32 v204, v204
  v_mfma_f32_16x16x32_bf16 v[196:199], v[36:39], v[172:175], 0
  ds_read_b128 v[60:63], v22 offset:20480
  v_mfma_f32_16x16x32_bf16 v[188:191], v[40:43], v[160:163], v[188:191]
  v_exp_f32 v205, v205
  v_mfma_f32_16x16x32_bf16 v[196:199], v[40:43], v[176:179], v[196:199]
  ds_read_b128 v[64:67], v23 offset:20480
  s_waitcnt lgkmcnt(4)
  v_mfma_f32_16x16x32_bf16 v[188:191], v[44:47], v[164:167], v[188:191]
  v_exp_f32 v206, v206
  ds_read_b64_tr_b16 v[36:37], v12 offset:0
  v_mfma_f32_16x16x32_bf16 v[196:199], v[44:47], v[180:183], v[196:199]
  v_add_f32 v148, v148, v204
  v_add_f32 v149, v149, v205
  ds_read_b64_tr_b16 v[38:39], v12 offset:4096
  v_mfma_f32_16x16x32_bf16 v[188:191], v[48:51], v[168:171], v[188:191]
  v_exp_f32 v207, v207
  ds_read_b64_tr_b16 v[40:41], v13 offset:0
  v_mfma_f32_16x16x32_bf16 v[196:199], v[48:51], v[184:187], v[196:199]
  s_add_u32 s62, s46, 57344
  s_add_u32 m0, s45, 57344
  ds_read_b64_tr_b16 v[42:43], v13 offset:4096
  buffer_load_dwordx4 v8, s[20:23], s62 offen lds
  s_waitcnt lgkmcnt(6)
  v_mfma_f32_16x16x32_bf16 v[192:195], v[52:55], v[156:159], 0
  v_exp_f32 v208, v208
  ds_read_b64_tr_b16 v[44:45], v14 offset:0
  v_mfma_f32_16x16x32_bf16 v[200:203], v[52:55], v[172:175], 0
  v_add_f32 v148, v148, v206
  v_add_f32 v149, v149, v207
  ds_read_b64_tr_b16 v[46:47], v14 offset:4096
  v_mfma_f32_16x16x32_bf16 v[192:195], v[56:59], v[160:163], v[192:195]
  v_exp_f32 v209, v209
  ds_read_b64_tr_b16 v[48:49], v15 offset:0
  v_mfma_f32_16x16x32_bf16 v[200:203], v[56:59], v[176:179], v[200:203]
  v_cvt_pk_bf16_f32 v140, v204, v205
  v_cvt_pk_bf16_f32 v141, v206, v207
  ds_read_b64_tr_b16 v[50:51], v15 offset:4096
  s_waitcnt lgkmcnt(8)
  v_mfma_f32_16x16x32_bf16 v[192:195], v[60:63], v[164:167], v[192:195]
  v_exp_f32 v210, v210
  ds_read_b64_tr_b16 v[52:53], v16 offset:0
  v_mfma_f32_16x16x32_bf16 v[200:203], v[60:63], v[180:183], v[200:203]
  v_add_f32 v148, v148, v208
  v_add_f32 v149, v149, v209
  ds_read_b64_tr_b16 v[54:55], v16 offset:4096
  v_mfma_f32_16x16x32_bf16 v[192:195], v[64:67], v[168:171], v[192:195]
  v_exp_f32 v211, v211
  ds_read_b64_tr_b16 v[56:57], v17 offset:0
  v_mfma_f32_16x16x32_bf16 v[200:203], v[64:67], v[184:187], v[200:203]
  ds_read_b64_tr_b16 v[58:59], v17 offset:4096
  buffer_load_dword v252, v253, s[12:15], s43 offen
  s_waitcnt lgkmcnt(8)
  v_mfma_f32_16x16x32_bf16 v[68:71], v[36:39], v[132:135], 0
  v_exp_f32 v212, v212
  ds_read_b64_tr_b16 v[60:61], v18 offset:0
  v_mfma_f32_16x16x32_bf16 v[72:75], v[36:39], v[136:139], 0
  v_add_f32 v148, v148, v210
  v_add_f32 v149, v149, v211
  ds_read_b64_tr_b16 v[62:63], v18 offset:4096
  v_mfma_f32_16x16x32_bf16 v[76:79], v[40:43], v[132:135], 0
  v_exp_f32 v213, v213
  ds_read_b64_tr_b16 v[64:65], v19 offset:0
  v_mfma_f32_16x16x32_bf16 v[80:83], v[40:43], v[136:139], 0
  v_cvt_pk_bf16_f32 v142, v208, v209
  v_cvt_pk_bf16_f32 v143, v210, v211
  ds_read_b64_tr_b16 v[66:67], v19 offset:4096
  s_waitcnt lgkmcnt(8)
  v_mfma_f32_16x16x32_bf16 v[84:87], v[44:47], v[132:135], 0
  v_exp_f32 v214, v214
  v_mfma_f32_16x16x32_bf16 v[88:91], v[44:47], v[136:139], 0
  v_add_f32 v150, v150, v212
  v_add_f32 v151, v151, v213
  ds_read_b128 v[36:39], v20 offset:24576
  v_mfma_f32_16x16x32_bf16 v[92:95], v[48:51], v[132:135], 0
  v_exp_f32 v215, v215
  v_mfma_f32_16x16x32_bf16 v[96:99], v[48:51], v[136:139], 0
  s_add_u32 s62, s46, 40960
  s_add_u32 m0, s45, 106496
  ds_read_b128 v[40:43], v21 offset:24576
  buffer_load_dwordx4 v9, s[24:27], s62 offen lds
  s_waitcnt lgkmcnt(6)
  v_mfma_f32_16x16x32_bf16 v[100:103], v[52:55], v[132:135], 0
  v_exp_f32 v216, v216
  v_mfma_f32_16x16x32_bf16 v[104:107], v[52:55], v[136:139], 0
  v_add_f32 v150, v150, v214
  v_add_f32 v151, v151, v215
  ds_read_b128 v[44:47], v22 offset:24576
  v_mfma_f32_16x16x32_bf16 v[108:111], v[56:59], v[132:135], 0
  v_exp_f32 v217, v217
  v_mfma_f32_16x16x32_bf16 v[112:115], v[56:59], v[136:139], 0
  v_cvt_pk_bf16_f32 v144, v212, v213
  v_cvt_pk_bf16_f32 v145, v214, v215
  ds_read_b128 v[48:51], v23 offset:24576
  s_waitcnt lgkmcnt(4)
  v_mfma_f32_16x16x32_bf16 v[116:119], v[60:63], v[132:135], 0
  v_exp_f32 v218, v218
  v_mfma_f32_16x16x32_bf16 v[120:123], v[60:63], v[136:139], 0
  v_add_f32 v150, v150, v216
  v_add_f32 v151, v151, v217
  ds_read_b128 v[52:55], v20 offset:28672
  v_mfma_f32_16x16x32_bf16 v[124:127], v[64:67], v[132:135], 0
  v_exp_f32 v219, v219
  v_mfma_f32_16x16x32_bf16 v[128:131], v[64:67], v[136:139], 0
  s_add_u32 s43, s43, 8192
  ds_read_b128 v[56:59], v21 offset:28672
  s_waitcnt lgkmcnt(4)
  v_mfma_f32_16x16x32_bf16 v[204:207], v[36:39], v[156:159], 0
  v_exp_f32 v188, v188
  v_mfma_f32_16x16x32_bf16 v[212:215], v[36:39], v[172:175], 0
  v_add_f32 v150, v150, v218
  v_add_f32 v151, v151, v219
  ds_read_b128 v[60:63], v22 offset:28672
  v_mfma_f32_16x16x32_bf16 v[204:207], v[40:43], v[160:163], v[204:207]
  v_exp_f32 v189, v189
  v_mfma_f32_16x16x32_bf16 v[212:215], v[40:43], v[176:179], v[212:215]
  v_cvt_pk_bf16_f32 v146, v216, v217
  v_cvt_pk_bf16_f32 v147, v218, v219
  ds_read_b128 v[64:67], v23 offset:28672
  s_waitcnt lgkmcnt(4)
  v_mfma_f32_16x16x32_bf16 v[204:207], v[44:47], v[164:167], v[204:207]
  v_exp_f32 v190, v190
  ds_read_b64_tr_b16 v[36:37], v12 offset:8192
  v_mfma_f32_16x16x32_bf16 v[212:215], v[44:47], v[180:183], v[212:215]
  v_add_f32 v148, v148, v188
  v_add_f32 v149, v149, v189
  ds_read_b64_tr_b16 v[38:39], v12 offset:12288
  v_mfma_f32_16x16x32_bf16 v[204:207], v[48:51], v[168:171], v[204:207]
  v_exp_f32 v191, v191
  ds_read_b64_tr_b16 v[40:41], v13 offset:8192
  v_mfma_f32_16x16x32_bf16 v[212:215], v[48:51], v[184:187], v[212:215]
  s_add_u32 s62, s46, 65536
  s_add_u32 m0, s45, 0
  ds_read_b64_tr_b16 v[42:43], v13 offset:12288
  buffer_load_dwordx4 v8, s[20:23], s62 offen lds
  s_waitcnt lgkmcnt(6)
  v_mfma_f32_16x16x32_bf16 v[208:211], v[52:55], v[156:159], 0
  v_exp_f32 v192, v192
  ds_read_b64_tr_b16 v[44:45], v14 offset:8192
  v_mfma_f32_16x16x32_bf16 v[216:219], v[52:55], v[172:175], 0
  v_add_f32 v148, v148, v190
  v_add_f32 v149, v149, v191
  ds_read_b64_tr_b16 v[46:47], v14 offset:12288
  v_mfma_f32_16x16x32_bf16 v[208:211], v[56:59], v[160:163], v[208:211]
  v_exp_f32 v193, v193
  ds_read_b64_tr_b16 v[48:49], v15 offset:8192
  v_mfma_f32_16x16x32_bf16 v[216:219], v[56:59], v[176:179], v[216:219]
  v_cvt_pk_bf16_f32 v132, v188, v189
  v_cvt_pk_bf16_f32 v133, v190, v191
  ds_read_b64_tr_b16 v[50:51], v15 offset:12288
  s_waitcnt lgkmcnt(8)
  v_mfma_f32_16x16x32_bf16 v[208:211], v[60:63], v[164:167], v[208:211]
  v_exp_f32 v194, v194
  ds_read_b64_tr_b16 v[52:53], v16 offset:8192
  v_mfma_f32_16x16x32_bf16 v[216:219], v[60:63], v[180:183], v[216:219]
  v_add_f32 v148, v148, v192
  v_add_f32 v149, v149, v193
  ds_read_b64_tr_b16 v[54:55], v16 offset:12288
  v_mfma_f32_16x16x32_bf16 v[208:211], v[64:67], v[168:171], v[208:211]
  v_exp_f32 v195, v195
  ds_read_b64_tr_b16 v[56:57], v17 offset:8192
  v_mfma_f32_16x16x32_bf16 v[216:219], v[64:67], v[184:187], v[216:219]
  ds_read_b64_tr_b16 v[58:59], v17 offset:12288
  s_waitcnt lgkmcnt(8)
  v_mfma_f32_16x16x32_bf16 v[68:71], v[36:39], v[140:143], v[68:71]
  v_exp_f32 v196, v196
  ds_read_b64_tr_b16 v[60:61], v18 offset:8192
  v_mfma_f32_16x16x32_bf16 v[72:75], v[36:39], v[144:147], v[72:75]
  v_add_f32 v148, v148, v194
  v_add_f32 v149, v149, v195
  ds_read_b64_tr_b16 v[62:63], v18 offset:12288
  v_mfma_f32_16x16x32_bf16 v[76:79], v[40:43], v[140:143], v[76:79]
  v_exp_f32 v197, v197
  ds_read_b64_tr_b16 v[64:65], v19 offset:8192
  v_mfma_f32_16x16x32_bf16 v[80:83], v[40:43], v[144:147], v[80:83]
  v_cvt_pk_bf16_f32 v134, v192, v193
  v_cvt_pk_bf16_f32 v135, v194, v195
  ds_read_b64_tr_b16 v[66:67], v19 offset:12288
  s_waitcnt lgkmcnt(8)
  v_mfma_f32_16x16x32_bf16 v[84:87], v[44:47], v[140:143], v[84:87]
  v_exp_f32 v198, v198
  v_mfma_f32_16x16x32_bf16 v[88:91], v[44:47], v[144:147], v[88:91]
  s_waitcnt vmcnt(6)
  s_barrier
  v_add_f32 v150, v150, v196
  v_add_f32 v151, v151, v197
  ds_read_b128 v[36:39], v20 offset:32768
  v_mfma_f32_16x16x32_bf16 v[92:95], v[48:51], v[140:143], v[92:95]
  v_exp_f32 v199, v199
  v_mfma_f32_16x16x32_bf16 v[96:99], v[48:51], v[144:147], v[96:99]
  s_add_u32 s62, s46, 49152
  s_add_u32 m0, s45, 114688
  ds_read_b128 v[40:43], v21 offset:32768
  buffer_load_dwordx4 v9, s[24:27], s62 offen lds
  s_waitcnt lgkmcnt(6)
  v_mfma_f32_16x16x32_bf16 v[100:103], v[52:55], v[140:143], v[100:103]
  v_exp_f32 v200, v200
  v_mfma_f32_16x16x32_bf16 v[104:107], v[52:55], v[144:147], v[104:107]
  v_add_f32 v150, v150, v198
  v_add_f32 v151, v151, v199
  ds_read_b128 v[44:47], v22 offset:32768
  v_mfma_f32_16x16x32_bf16 v[108:111], v[56:59], v[140:143], v[108:111]
  v_exp_f32 v201, v201
  v_mfma_f32_16x16x32_bf16 v[112:115], v[56:59], v[144:147], v[112:115]
  v_cvt_pk_bf16_f32 v136, v196, v197
  v_cvt_pk_bf16_f32 v137, v198, v199
  ds_read_b128 v[48:51], v23 offset:32768
  s_waitcnt lgkmcnt(4)
  v_mfma_f32_16x16x32_bf16 v[116:119], v[60:63], v[140:143], v[116:119]
  v_exp_f32 v202, v202
  v_mfma_f32_16x16x32_bf16 v[120:123], v[60:63], v[144:147], v[120:123]
  v_add_f32 v150, v150, v200
  v_add_f32 v151, v151, v201
  ds_read_b128 v[52:55], v20 offset:36864
  v_mfma_f32_16x16x32_bf16 v[124:127], v[64:67], v[140:143], v[124:127]
  v_exp_f32 v203, v203
  v_mfma_f32_16x16x32_bf16 v[128:131], v[64:67], v[144:147], v[128:131]
  ds_read_b128 v[56:59], v21 offset:36864
  s_waitcnt lgkmcnt(4)
  v_mfma_f32_16x16x32_bf16 v[188:191], v[36:39], v[156:159], 0
  v_exp_f32 v204, v204
  v_mfma_f32_16x16x32_bf16 v[196:199], v[36:39], v[172:175], 0
  v_add_f32 v150, v150, v202
  v_add_f32 v151, v151, v203
  ds_read_b128 v[60:63], v22 offset:36864
  v_mfma_f32_16x16x32_bf16 v[188:191], v[40:43], v[160:163], v[188:191]
  v_exp_f32 v205, v205
  v_mfma_f32_16x16x32_bf16 v[196:199], v[40:43], v[176:179], v[196:199]
  v_cvt_pk_bf16_f32 v138, v200, v201
  v_cvt_pk_bf16_f32 v139, v202, v203
  ds_read_b128 v[64:67], v23 offset:36864
  s_waitcnt lgkmcnt(4)
  v_mfma_f32_16x16x32_bf16 v[188:191], v[44:47], v[164:167], v[188:191]
  v_exp_f32 v206, v206
  ds_read_b64_tr_b16 v[36:37], v12 offset:16384
  v_mfma_f32_16x16x32_bf16 v[196:199], v[44:47], v[180:183], v[196:199]
  v_add_f32 v148, v148, v204
  v_add_f32 v149, v149, v205
  ds_read_b64_tr_b16 v[38:39], v12 offset:20480
  v_mfma_f32_16x16x32_bf16 v[188:191], v[48:51], v[168:171], v[188:191]
  v_exp_f32 v207, v207
  ds_read_b64_tr_b16 v[40:41], v13 offset:16384
  v_mfma_f32_16x16x32_bf16 v[196:199], v[48:51], v[184:187], v[196:199]
  s_add_u32 s62, s46, 73728
  s_add_u32 m0, s45, 8192
  ds_read_b64_tr_b16 v[42:43], v13 offset:20480
  buffer_load_dwordx4 v8, s[20:23], s62 offen lds
  s_waitcnt lgkmcnt(6)
  v_mfma_f32_16x16x32_bf16 v[192:195], v[52:55], v[156:159], 0
  v_exp_f32 v208, v208
  ds_read_b64_tr_b16 v[44:45], v14 offset:16384
  v_mfma_f32_16x16x32_bf16 v[200:203], v[52:55], v[172:175], 0
  v_add_f32 v148, v148, v206
  v_add_f32 v149, v149, v207
  ds_read_b64_tr_b16 v[46:47], v14 offset:20480
  v_mfma_f32_16x16x32_bf16 v[192:195], v[56:59], v[160:163], v[192:195]
  v_exp_f32 v209, v209
  ds_read_b64_tr_b16 v[48:49], v15 offset:16384
  v_mfma_f32_16x16x32_bf16 v[200:203], v[56:59], v[176:179], v[200:203]
  v_cvt_pk_bf16_f32 v140, v204, v205
  v_cvt_pk_bf16_f32 v141, v206, v207
  ds_read_b64_tr_b16 v[50:51], v15 offset:20480
  s_waitcnt lgkmcnt(8)
  v_mfma_f32_16x16x32_bf16 v[192:195], v[60:63], v[164:167], v[192:195]
  v_exp_f32 v210, v210
  ds_read_b64_tr_b16 v[52:53], v16 offset:16384
  v_mfma_f32_16x16x32_bf16 v[200:203], v[60:63], v[180:183], v[200:203]
  v_add_f32 v148, v148, v208
  v_add_f32 v149, v149, v209
  ds_read_b64_tr_b16 v[54:55], v16 offset:20480
  v_mfma_f32_16x16x32_bf16 v[192:195], v[64:67], v[168:171], v[192:195]
  v_exp_f32 v211, v211
  ds_read_b64_tr_b16 v[56:57], v17 offset:16384
  v_mfma_f32_16x16x32_bf16 v[200:203], v[64:67], v[184:187], v[200:203]
  ds_read_b64_tr_b16 v[58:59], v17 offset:20480
  buffer_load_dword v252, v253, s[12:15], s43 offen
  s_waitcnt lgkmcnt(8)
  v_mfma_f32_16x16x32_bf16 v[68:71], v[36:39], v[132:135], v[68:71]
  v_exp_f32 v212, v212
  ds_read_b64_tr_b16 v[60:61], v18 offset:16384
  v_mfma_f32_16x16x32_bf16 v[72:75], v[36:39], v[136:139], v[72:75]
  v_add_f32 v148, v148, v210
  v_add_f32 v149, v149, v211
  ds_read_b64_tr_b16 v[62:63], v18 offset:20480
  v_mfma_f32_16x16x32_bf16 v[76:79], v[40:43], v[132:135], v[76:79]
  v_exp_f32 v213, v213
  ds_read_b64_tr_b16 v[64:65], v19 offset:16384
  v_mfma_f32_16x16x32_bf16 v[80:83], v[40:43], v[136:139], v[80:83]
  v_cvt_pk_bf16_f32 v142, v208, v209
  v_cvt_pk_bf16_f32 v143, v210, v211
  ds_read_b64_tr_b16 v[66:67], v19 offset:20480
  s_waitcnt lgkmcnt(8)
  v_mfma_f32_16x16x32_bf16 v[84:87], v[44:47], v[132:135], v[84:87]
  v_exp_f32 v214, v214
  v_mfma_f32_16x16x32_bf16 v[88:91], v[44:47], v[136:139], v[88:91]
  v_add_f32 v150, v150, v212
  v_add_f32 v151, v151, v213
  ds_read_b128 v[36:39], v20 offset:40960
  v_mfma_f32_16x16x32_bf16 v[92:95], v[48:51], v[132:135], v[92:95]
  v_exp_f32 v215, v215
  v_mfma_f32_16x16x32_bf16 v[96:99], v[48:51], v[136:139], v[96:99]
  s_add_u32 s62, s46, 57344
  s_add_u32 m0, s45, 122880
  ds_read_b128 v[40:43], v21 offset:40960
  buffer_load_dwordx4 v9, s[24:27], s62 offen lds
  s_waitcnt lgkmcnt(6)
  v_mfma_f32_16x16x32_bf16 v[100:103], v[52:55], v[132:135], v[100:103]
  v_exp_f32 v216, v216
  v_mfma_f32_16x16x32_bf16 v[104:107], v[52:55], v[136:139], v[104:107]
  v_add_f32 v150, v150, v214
  v_add_f32 v151, v151, v215
  ds_read_b128 v[44:47], v22 offset:40960
  v_mfma_f32_16x16x32_bf16 v[108:111], v[56:59], v[132:135], v[108:111]
  v_exp_f32 v217, v217
  v_mfma_f32_16x16x32_bf16 v[112:115], v[56:59], v[136:139], v[112:115]
  v_cvt_pk_bf16_f32 v144, v212, v213
  v_cvt_pk_bf16_f32 v145, v214, v215
  ds_read_b128 v[48:51], v23 offset:40960
  s_waitcnt lgkmcnt(4)
  v_mfma_f32_16x16x32_bf16 v[116:119], v[60:63], v[132:135], v[116:119]
  v_exp_f32 v218, v218
  v_mfma_f32_16x16x32_bf16 v[120:123], v[60:63], v[136:139], v[120:123]
  v_add_f32 v150, v150, v216
  v_add_f32 v151, v151, v217
  ds_read_b128 v[52:55], v20 offset:45056
  v_mfma_f32_16x16x32_bf16 v[124:127], v[64:67], v[132:135], v[124:127]
  v_exp_f32 v219, v219
  v_mfma_f32_16x16x32_bf16 v[128:131], v[64:67], v[136:139], v[128:131]
  s_add_u32 s43, s43, 8192
  ds_read_b128 v[56:59], v21 offset:45056
  s_waitcnt lgkmcnt(4)
  v_mfma_f32_16x16x32_bf16 v[204:207], v[36:39], v[156:159], 0
  v_exp_f32 v188, v188
  v_mfma_f32_16x16x32_bf16 v[212:215], v[36:39], v[172:175], 0
  v_add_f32 v150, v150, v218
  v_add_f32 v151, v151, v219
  ds_read_b128 v[60:63], v22 offset:45056
  v_mfma_f32_16x16x32_bf16 v[204:207], v[40:43], v[160:163], v[204:207]
  v_exp_f32 v189, v189
  v_mfma_f32_16x16x32_bf16 v[212:215], v[40:43], v[176:179], v[212:215]
  v_cvt_pk_bf16_f32 v146, v216, v217
  v_cvt_pk_bf16_f32 v147, v218, v219
  ds_read_b128 v[64:67], v23 offset:45056
  s_waitcnt lgkmcnt(4)
  v_mfma_f32_16x16x32_bf16 v[204:207], v[44:47], v[164:167], v[204:207]
  v_exp_f32 v190, v190
  ds_read_b64_tr_b16 v[36:37], v12 offset:24576
  v_mfma_f32_16x16x32_bf16 v[212:215], v[44:47], v[180:183], v[212:215]
  v_add_f32 v148, v148, v188
  v_add_f32 v149, v149, v189
  ds_read_b64_tr_b16 v[38:39], v12 offset:28672
  v_mfma_f32_16x16x32_bf16 v[204:207], v[48:51], v[168:171], v[204:207]
  v_exp_f32 v191, v191
  ds_read_b64_tr_b16 v[40:41], v13 offset:24576
  v_mfma_f32_16x16x32_bf16 v[212:215], v[48:51], v[184:187], v[212:215]
  s_add_u32 s62, s46, 81920
  s_add_u32 m0, s45, 16384
  ds_read_b64_tr_b16 v[42:43], v13 offset:28672
  buffer_load_dwordx4 v8, s[20:23], s62 offen lds
  s_waitcnt lgkmcnt(6)
  v_mfma_f32_16x16x32_bf16 v[208:211], v[52:55], v[156:159], 0
  v_exp_f32 v192, v192
  ds_read_b64_tr_b16 v[44:45], v14 offset:24576
  v_mfma_f32_16x16x32_bf16 v[216:219], v[52:55], v[172:175], 0
  v_add_f32 v148, v148, v190
  v_add_f32 v149, v149, v191
  ds_read_b64_tr_b16 v[46:47], v14 offset:28672
  v_mfma_f32_16x16x32_bf16 v[208:211], v[56:59], v[160:163], v[208:211]
  v_exp_f32 v193, v193
  ds_read_b64_tr_b16 v[48:49], v15 offset:24576
  v_mfma_f32_16x16x32_bf16 v[216:219], v[56:59], v[176:179], v[216:219]
  v_cvt_pk_bf16_f32 v132, v188, v189
  v_cvt_pk_bf16_f32 v133, v190, v191
  ds_read_b64_tr_b16 v[50:51], v15 offset:28672
  s_waitcnt lgkmcnt(8)
  v_mfma_f32_16x16x32_bf16 v[208:211], v[60:63], v[164:167], v[208:211]
  v_exp_f32 v194, v194
  ds_read_b64_tr_b16 v[52:53], v16 offset:24576
  v_mfma_f32_16x16x32_bf16 v[216:219], v[60:63], v[180:183], v[216:219]
  v_add_f32 v148, v148, v192
  v_add_f32 v149, v149, v193
  ds_read_b64_tr_b16 v[54:55], v16 offset:28672
  v_mfma_f32_16x16x32_bf16 v[208:211], v[64:67], v[168:171], v[208:211]
  v_exp_f32 v195, v195
  ds_read_b64_tr_b16 v[56:57], v17 offset:24576
  v_mfma_f32_16x16x32_bf16 v[216:219], v[64:67], v[184:187], v[216:219]
  ds_read_b64_tr_b16 v[58:59], v17 offset:28672
  s_waitcnt lgkmcnt(8)
  v_mfma_f32_16x16x32_bf16 v[68:71], v[36:39], v[140:143], v[68:71]
  v_exp_f32 v196, v196
  ds_read_b64_tr_b16 v[60:61], v18 offset:24576
  v_mfma_f32_16x16x32_bf16 v[72:75], v[36:39], v[144:147], v[72:75]
  v_add_f32 v148, v148, v194
  v_add_f32 v149, v149, v195
  ds_read_b64_tr_b16 v[62:63], v18 offset:28672
  v_mfma_f32_16x16x32_bf16 v[76:79], v[40:43], v[140:143], v[76:79]
  v_exp_f32 v197, v197
  ds_read_b64_tr_b16 v[64:65], v19 offset:24576
  v_mfma_f32_16x16x32_bf16 v[80:83], v[40:43], v[144:147], v[80:83]
  v_cvt_pk_bf16_f32 v134, v192, v193
  v_cvt_pk_bf16_f32 v135, v194, v195
  ds_read_b64_tr_b16 v[66:67], v19 offset:28672
  s_waitcnt lgkmcnt(8)
  v_mfma_f32_16x16x32_bf16 v[84:87], v[44:47], v[140:143], v[84:87]
  v_exp_f32 v198, v198
  v_mfma_f32_16x16x32_bf16 v[88:91], v[44:47], v[144:147], v[88:91]
  s_waitcnt vmcnt(6)
  s_barrier
  v_add_f32 v150, v150, v196
  v_add_f32 v151, v151, v197
  ds_read_b128 v[36:39], v20 offset:49152
  v_mfma_f32_16x16x32_bf16 v[92:95], v[48:51], v[140:143], v[92:95]
  v_exp_f32 v199, v199
  v_mfma_f32_16x16x32_bf16 v[96:99], v[48:51], v[144:147], v[96:99]
  s_add_u32 s62, s46, 65536
  s_add_u32 m0, s45, 65536
  ds_read_b128 v[40:43], v21 offset:49152
  buffer_load_dwordx4 v9, s[24:27], s62 offen lds
  s_waitcnt lgkmcnt(6)
  v_mfma_f32_16x16x32_bf16 v[100:103], v[52:55], v[140:143], v[100:103]
  v_exp_f32 v200, v200
  v_mfma_f32_16x16x32_bf16 v[104:107], v[52:55], v[144:147], v[104:107]
  v_add_f32 v150, v150, v198
  v_add_f32 v151, v151, v199
  ds_read_b128 v[44:47], v22 offset:49152
  v_mfma_f32_16x16x32_bf16 v[108:111], v[56:59], v[140:143], v[108:111]
  v_exp_f32 v201, v201
  v_mfma_f32_16x16x32_bf16 v[112:115], v[56:59], v[144:147], v[112:115]
  v_cvt_pk_bf16_f32 v136, v196, v197
  v_cvt_pk_bf16_f32 v137, v198, v199
  ds_read_b128 v[48:51], v23 offset:49152
  s_waitcnt lgkmcnt(4)
  v_mfma_f32_16x16x32_bf16 v[116:119], v[60:63], v[140:143], v[116:119]
  v_exp_f32 v202, v202
  v_mfma_f32_16x16x32_bf16 v[120:123], v[60:63], v[144:147], v[120:123]
  v_add_f32 v150, v150, v200
  v_add_f32 v151, v151, v201
  ds_read_b128 v[52:55], v20 offset:53248
  v_mfma_f32_16x16x32_bf16 v[124:127], v[64:67], v[140:143], v[124:127]
  v_exp_f32 v203, v203
  v_mfma_f32_16x16x32_bf16 v[128:131], v[64:67], v[144:147], v[128:131]
  ds_read_b128 v[56:59], v21 offset:53248
  s_waitcnt lgkmcnt(4)
  v_mfma_f32_16x16x32_bf16 v[188:191], v[36:39], v[156:159], 0
  v_exp_f32 v204, v204
  v_mfma_f32_16x16x32_bf16 v[196:199], v[36:39], v[172:175], 0
  v_add_f32 v150, v150, v202
  v_add_f32 v151, v151, v203
  ds_read_b128 v[60:63], v22 offset:53248
  v_mfma_f32_16x16x32_bf16 v[188:191], v[40:43], v[160:163], v[188:191]
  v_exp_f32 v205, v205
  v_mfma_f32_16x16x32_bf16 v[196:199], v[40:43], v[176:179], v[196:199]
  v_cvt_pk_bf16_f32 v138, v200, v201
  v_cvt_pk_bf16_f32 v139, v202, v203
  ds_read_b128 v[64:67], v23 offset:53248
  s_waitcnt lgkmcnt(4)
  v_mfma_f32_16x16x32_bf16 v[188:191], v[44:47], v[164:167], v[188:191]
  v_exp_f32 v206, v206
  ds_read_b64_tr_b16 v[36:37], v12 offset:32768
  v_mfma_f32_16x16x32_bf16 v[196:199], v[44:47], v[180:183], v[196:199]
  v_add_f32 v148, v148, v204
  v_add_f32 v149, v149, v205
  ds_read_b64_tr_b16 v[38:39], v12 offset:36864
  v_mfma_f32_16x16x32_bf16 v[188:191], v[48:51], v[168:171], v[188:191]
  v_exp_f32 v207, v207
  ds_read_b64_tr_b16 v[40:41], v13 offset:32768
  v_mfma_f32_16x16x32_bf16 v[196:199], v[48:51], v[184:187], v[196:199]
  s_add_u32 s62, s46, 90112
  s_add_u32 m0, s45, 24576
  ds_read_b64_tr_b16 v[42:43], v13 offset:36864
  buffer_load_dwordx4 v8, s[20:23], s62 offen lds
  s_waitcnt lgkmcnt(6)
  v_mfma_f32_16x16x32_bf16 v[192:195], v[52:55], v[156:159], 0
  v_exp_f32 v208, v208
  ds_read_b64_tr_b16 v[44:45], v14 offset:32768
  v_mfma_f32_16x16x32_bf16 v[200:203], v[52:55], v[172:175], 0
  v_add_f32 v148, v148, v206
  v_add_f32 v149, v149, v207
  ds_read_b64_tr_b16 v[46:47], v14 offset:36864
  v_mfma_f32_16x16x32_bf16 v[192:195], v[56:59], v[160:163], v[192:195]
  v_exp_f32 v209, v209
  ds_read_b64_tr_b16 v[48:49], v15 offset:32768
  v_mfma_f32_16x16x32_bf16 v[200:203], v[56:59], v[176:179], v[200:203]
  v_cvt_pk_bf16_f32 v140, v204, v205
  v_cvt_pk_bf16_f32 v141, v206, v207
  ds_read_b64_tr_b16 v[50:51], v15 offset:36864
  s_waitcnt lgkmcnt(8)
  v_mfma_f32_16x16x32_bf16 v[192:195], v[60:63], v[164:167], v[192:195]
  v_exp_f32 v210, v210
  ds_read_b64_tr_b16 v[52:53], v16 offset:32768
  v_mfma_f32_16x16x32_bf16 v[200:203], v[60:63], v[180:183], v[200:203]
  v_add_f32 v148, v148, v208
  v_add_f32 v149, v149, v209
  ds_read_b64_tr_b16 v[54:55], v16 offset:36864
  v_mfma_f32_16x16x32_bf16 v[192:195], v[64:67], v[168:171], v[192:195]
  v_exp_f32 v211, v211
  ds_read_b64_tr_b16 v[56:57], v17 offset:32768
  v_mfma_f32_16x16x32_bf16 v[200:203], v[64:67], v[184:187], v[200:203]
  ds_read_b64_tr_b16 v[58:59], v17 offset:36864
  buffer_load_dword v252, v253, s[12:15], s43 offen
  s_waitcnt lgkmcnt(8)
  v_mfma_f32_16x16x32_bf16 v[68:71], v[36:39], v[132:135], v[68:71]
  v_exp_f32 v212, v212
  ds_read_b64_tr_b16 v[60:61], v18 offset:32768
  v_mfma_f32_16x16x32_bf16 v[72:75], v[36:39], v[136:139], v[72:75]
  v_add_f32 v148, v148, v210
  v_add_f32 v149, v149, v211
  ds_read_b64_tr_b16 v[62:63], v18 offset:36864
  v_mfma_f32_16x16x32_bf16 v[76:79], v[40:43], v[132:135], v[76:79]
  v_exp_f32 v213, v213
  ds_read_b64_tr_b16 v[64:65], v19 offset:32768
  v_mfma_f32_16x16x32_bf16 v[80:83], v[40:43], v[136:139], v[80:83]
  v_cvt_pk_bf16_f32 v142, v208, v209
  v_cvt_pk_bf16_f32 v143, v210, v211
  ds_read_b64_tr_b16 v[66:67], v19 offset:36864
  s_waitcnt lgkmcnt(8)
  v_mfma_f32_16x16x32_bf16 v[84:87], v[44:47], v[132:135], v[84:87]
  v_exp_f32 v214, v214
  v_mfma_f32_16x16x32_bf16 v[88:91], v[44:47], v[136:139], v[88:91]
  v_add_f32 v150, v150, v212
  v_add_f32 v151, v151, v213
  ds_read_b128 v[36:39], v20 offset:57344
  v_mfma_f32_16x16x32_bf16 v[92:95], v[48:51], v[132:135], v[92:95]
  v_exp_f32 v215, v215
  v_mfma_f32_16x16x32_bf16 v[96:99], v[48:51], v[136:139], v[96:99]
  s_add_u32 s62, s46, 73728
  s_add_u32 m0, s45, 73728
  ds_read_b128 v[40:43], v21 offset:57344
  buffer_load_dwordx4 v9, s[24:27], s62 offen lds
  s_waitcnt lgkmcnt(6)
  v_mfma_f32_16x16x32_bf16 v[100:103], v[52:55], v[132:135], v[100:103]
  v_exp_f32 v216, v216
  v_mfma_f32_16x16x32_bf16 v[104:107], v[52:55], v[136:139], v[104:107]
  v_add_f32 v150, v150, v214
  v_add_f32 v151, v151, v215
  ds_read_b128 v[44:47], v22 offset:57344
  v_mfma_f32_16x16x32_bf16 v[108:111], v[56:59], v[132:135], v[108:111]
  v_exp_f32 v217, v217
  v_mfma_f32_16x16x32_bf16 v[112:115], v[56:59], v[136:139], v[112:115]
  v_cvt_pk_bf16_f32 v144, v212, v213
  v_cvt_pk_bf16_f32 v145, v214, v215
  ds_read_b128 v[48:51], v23 offset:57344
  buffer_store_dwordx4 v[236:239], v27, s[28:31], s48 offen sc1
  s_waitcnt lgkmcnt(4)
  v_mfma_f32_16x16x32_bf16 v[116:119], v[60:63], v[132:135], v[116:119]
  v_exp_f32 v218, v218
  v_mfma_f32_16x16x32_bf16 v[120:123], v[60:63], v[136:139], v[120:123]
  v_add_f32 v150, v150, v216
  v_add_f32 v151, v151, v217
  ds_read_b128 v[52:55], v20 offset:61440
  v_mfma_f32_16x16x32_bf16 v[124:127], v[64:67], v[132:135], v[124:127]
  v_exp_f32 v219, v219
  v_mfma_f32_16x16x32_bf16 v[128:131], v[64:67], v[136:139], v[128:131]
  s_add_u32 s43, s43, 8192
  ds_read_b128 v[56:59], v21 offset:61440
  s_waitcnt lgkmcnt(4)
  v_mfma_f32_16x16x32_bf16 v[204:207], v[36:39], v[156:159], 0
  v_exp_f32 v188, v188
  v_mfma_f32_16x16x32_bf16 v[212:215], v[36:39], v[172:175], 0
  v_add_f32 v150, v150, v218
  v_add_f32 v151, v151, v219
  ds_read_b128 v[60:63], v22 offset:61440
  v_mfma_f32_16x16x32_bf16 v[204:207], v[40:43], v[160:163], v[204:207]
  v_exp_f32 v189, v189
  v_mfma_f32_16x16x32_bf16 v[212:215], v[40:43], v[176:179], v[212:215]
  v_cvt_pk_bf16_f32 v146, v216, v217
  v_cvt_pk_bf16_f32 v147, v218, v219
  ds_read_b128 v[64:67], v23 offset:61440
  s_waitcnt lgkmcnt(4)
  v_mfma_f32_16x16x32_bf16 v[204:207], v[44:47], v[164:167], v[204:207]
  v_exp_f32 v190, v190
  ds_read_b64_tr_b16 v[36:37], v12 offset:40960
  v_mfma_f32_16x16x32_bf16 v[212:215], v[44:47], v[180:183], v[212:215]
  v_add_f32 v148, v148, v188
  v_add_f32 v149, v149, v189
  ds_read_b64_tr_b16 v[38:39], v12 offset:45056
  v_mfma_f32_16x16x32_bf16 v[204:207], v[48:51], v[168:171], v[204:207]
  v_exp_f32 v191, v191
  ds_read_b64_tr_b16 v[40:41], v13 offset:40960
  v_mfma_f32_16x16x32_bf16 v[212:215], v[48:51], v[184:187], v[212:215]
  s_add_u32 s62, s46, 98304
  s_add_u32 m0, s45, 32768
  ds_read_b64_tr_b16 v[42:43], v13 offset:45056
  buffer_load_dwordx4 v8, s[20:23], s62 offen lds
  s_waitcnt lgkmcnt(6)
  v_mfma_f32_16x16x32_bf16 v[208:211], v[52:55], v[156:159], 0
  v_exp_f32 v192, v192
  ds_read_b64_tr_b16 v[44:45], v14 offset:40960
  v_mfma_f32_16x16x32_bf16 v[216:219], v[52:55], v[172:175], 0
  v_add_f32 v148, v148, v190
  v_add_f32 v149, v149, v191
  ds_read_b64_tr_b16 v[46:47], v14 offset:45056
  v_mfma_f32_16x16x32_bf16 v[208:211], v[56:59], v[160:163], v[208:211]
  v_exp_f32 v193, v193
  ds_read_b64_tr_b16 v[48:49], v15 offset:40960
  v_mfma_f32_16x16x32_bf16 v[216:219], v[56:59], v[176:179], v[216:219]
  v_cvt_pk_bf16_f32 v132, v188, v189
  v_cvt_pk_bf16_f32 v133, v190, v191
  ds_read_b64_tr_b16 v[50:51], v15 offset:45056
  s_waitcnt lgkmcnt(8)
  v_mfma_f32_16x16x32_bf16 v[208:211], v[60:63], v[164:167], v[208:211]
  v_exp_f32 v194, v194
  ds_read_b64_tr_b16 v[52:53], v16 offset:40960
  v_mfma_f32_16x16x32_bf16 v[216:219], v[60:63], v[180:183], v[216:219]
  v_add_f32 v148, v148, v192
  v_add_f32 v149, v149, v193
  ds_read_b64_tr_b16 v[54:55], v16 offset:45056
  v_mfma_f32_16x16x32_bf16 v[208:211], v[64:67], v[168:171], v[208:211]
  v_exp_f32 v195, v195
  ds_read_b64_tr_b16 v[56:57], v17 offset:40960
  v_mfma_f32_16x16x32_bf16 v[216:219], v[64:67], v[184:187], v[216:219]
  ds_read_b64_tr_b16 v[58:59], v17 offset:45056
  s_waitcnt lgkmcnt(8)
  v_mfma_f32_16x16x32_bf16 v[68:71], v[36:39], v[140:143], v[68:71]
  v_exp_f32 v196, v196
  ds_read_b64_tr_b16 v[60:61], v18 offset:40960
  v_mfma_f32_16x16x32_bf16 v[72:75], v[36:39], v[144:147], v[72:75]
  v_add_f32 v148, v148, v194
  v_add_f32 v149, v149, v195
  ds_read_b64_tr_b16 v[62:63], v18 offset:45056
  v_mfma_f32_16x16x32_bf16 v[76:79], v[40:43], v[140:143], v[76:79]
  v_exp_f32 v197, v197
  ds_read_b64_tr_b16 v[64:65], v19 offset:40960
  v_mfma_f32_16x16x32_bf16 v[80:83], v[40:43], v[144:147], v[80:83]
  v_cvt_pk_bf16_f32 v134, v192, v193
  v_cvt_pk_bf16_f32 v135, v194, v195
  ds_read_b64_tr_b16 v[66:67], v19 offset:45056
  s_waitcnt lgkmcnt(8)
  v_mfma_f32_16x16x32_bf16 v[84:87], v[44:47], v[140:143], v[84:87]
  v_exp_f32 v198, v198
  v_mfma_f32_16x16x32_bf16 v[88:91], v[44:47], v[144:147], v[88:91]
  s_waitcnt vmcnt(7)
  s_barrier
  v_add_f32 v150, v150, v196
  v_add_f32 v151, v151, v197
  ds_read_b128 v[36:39], v20 offset:0
  v_mfma_f32_16x16x32_bf16 v[92:95], v[48:51], v[140:143], v[92:95]
  v_exp_f32 v199, v199
  v_mfma_f32_16x16x32_bf16 v[96:99], v[48:51], v[144:147], v[96:99]
  s_add_u32 s62, s46, 81920
  s_add_u32 m0, s45, 81920
  ds_read_b128 v[40:43], v21 offset:0
  buffer_load_dwordx4 v9, s[24:27], s62 offen lds
  s_waitcnt lgkmcnt(6)
  v_mfma_f32_16x16x32_bf16 v[100:103], v[52:55], v[140:143], v[100:103]
  v_exp_f32 v200, v200
  v_mfma_f32_16x16x32_bf16 v[104:107], v[52:55], v[144:147], v[104:107]
  v_add_f32 v150, v150, v198
  v_add_f32 v151, v151, v199
  ds_read_b128 v[44:47], v22 offset:0
  v_mfma_f32_16x16x32_bf16 v[108:111], v[56:59], v[140:143], v[108:111]
  v_exp_f32 v201, v201
  v_mfma_f32_16x16x32_bf16 v[112:115], v[56:59], v[144:147], v[112:115]
  v_cvt_pk_bf16_f32 v136, v196, v197
  v_cvt_pk_bf16_f32 v137, v198, v199
  ds_read_b128 v[48:51], v23 offset:0
  buffer_store_dwordx4 v[240:243], v27, s[28:31], s49 offen sc1
  s_waitcnt lgkmcnt(4)
  v_mfma_f32_16x16x32_bf16 v[116:119], v[60:63], v[140:143], v[116:119]
  v_exp_f32 v202, v202
  v_mfma_f32_16x16x32_bf16 v[120:123], v[60:63], v[144:147], v[120:123]
  v_add_f32 v150, v150, v200
  v_add_f32 v151, v151, v201
  ds_read_b128 v[52:55], v20 offset:4096
  v_mfma_f32_16x16x32_bf16 v[124:127], v[64:67], v[140:143], v[124:127]
  v_exp_f32 v203, v203
  v_mfma_f32_16x16x32_bf16 v[128:131], v[64:67], v[144:147], v[128:131]
  ds_read_b128 v[56:59], v21 offset:4096
  s_waitcnt lgkmcnt(4)
  v_mfma_f32_16x16x32_bf16 v[188:191], v[36:39], v[156:159], 0
  v_exp_f32 v204, v204
  v_mfma_f32_16x16x32_bf16 v[196:199], v[36:39], v[172:175], 0
  v_add_f32 v150, v150, v202
  v_add_f32 v151, v151, v203
  ds_read_b128 v[60:63], v22 offset:4096
  v_mfma_f32_16x16x32_bf16 v[188:191], v[40:43], v[160:163], v[188:191]
  v_exp_f32 v205, v205
  v_mfma_f32_16x16x32_bf16 v[196:199], v[40:43], v[176:179], v[196:199]
  v_cvt_pk_bf16_f32 v138, v200, v201
  v_cvt_pk_bf16_f32 v139, v202, v203
  ds_read_b128 v[64:67], v23 offset:4096
  s_waitcnt lgkmcnt(4)
  v_mfma_f32_16x16x32_bf16 v[188:191], v[44:47], v[164:167], v[188:191]
  v_exp_f32 v206, v206
  ds_read_b64_tr_b16 v[36:37], v12 offset:49152
  v_mfma_f32_16x16x32_bf16 v[196:199], v[44:47], v[180:183], v[196:199]
  v_add_f32 v148, v148, v204
  v_add_f32 v149, v149, v205
  ds_read_b64_tr_b16 v[38:39], v12 offset:53248
  v_mfma_f32_16x16x32_bf16 v[188:191], v[48:51], v[168:171], v[188:191]
  v_exp_f32 v207, v207
  ds_read_b64_tr_b16 v[40:41], v13 offset:49152
  v_mfma_f32_16x16x32_bf16 v[196:199], v[48:51], v[184:187], v[196:199]
  s_add_u32 s62, s46, 106496
  s_add_u32 m0, s45, 40960
  ds_read_b64_tr_b16 v[42:43], v13 offset:53248
  buffer_load_dwordx4 v8, s[20:23], s62 offen lds
  s_waitcnt lgkmcnt(6)
  v_mfma_f32_16x16x32_bf16 v[192:195], v[52:55], v[156:159], 0
  v_exp_f32 v208, v208
  ds_read_b64_tr_b16 v[44:45], v14 offset:49152
  v_mfma_f32_16x16x32_bf16 v[200:203], v[52:55], v[172:175], 0
  v_add_f32 v148, v148, v206
  v_add_f32 v149, v149, v207
  ds_read_b64_tr_b16 v[46:47], v14 offset:53248
  v_mfma_f32_16x16x32_bf16 v[192:195], v[56:59], v[160:163], v[192:195]
  v_exp_f32 v209, v209
  ds_read_b64_tr_b16 v[48:49], v15 offset:49152
  v_mfma_f32_16x16x32_bf16 v[200:203], v[56:59], v[176:179], v[200:203]
  v_cvt_pk_bf16_f32 v140, v204, v205
  v_cvt_pk_bf16_f32 v141, v206, v207
  ds_read_b64_tr_b16 v[50:51], v15 offset:53248
  s_waitcnt lgkmcnt(8)
  v_mfma_f32_16x16x32_bf16 v[192:195], v[60:63], v[164:167], v[192:195]
  v_exp_f32 v210, v210
  ds_read_b64_tr_b16 v[52:53], v16 offset:49152
  v_mfma_f32_16x16x32_bf16 v[200:203], v[60:63], v[180:183], v[200:203]
  v_add_f32 v148, v148, v208
  v_add_f32 v149, v149, v209
  ds_read_b64_tr_b16 v[54:55], v16 offset:53248
  v_mfma_f32_16x16x32_bf16 v[192:195], v[64:67], v[168:171], v[192:195]
  v_exp_f32 v211, v211
  ds_read_b64_tr_b16 v[56:57], v17 offset:49152
  v_mfma_f32_16x16x32_bf16 v[200:203], v[64:67], v[184:187], v[200:203]
  ds_read_b64_tr_b16 v[58:59], v17 offset:53248
  buffer_load_dword v252, v253, s[12:15], s43 offen
  s_waitcnt lgkmcnt(8)
  v_mfma_f32_16x16x32_bf16 v[68:71], v[36:39], v[132:135], v[68:71]
  v_exp_f32 v212, v212
  ds_read_b64_tr_b16 v[60:61], v18 offset:49152
  v_mfma_f32_16x16x32_bf16 v[72:75], v[36:39], v[136:139], v[72:75]
  v_add_f32 v148, v148, v210
  v_add_f32 v149, v149, v211
  ds_read_b64_tr_b16 v[62:63], v18 offset:53248
  v_mfma_f32_16x16x32_bf16 v[76:79], v[40:43], v[132:135], v[76:79]
  v_exp_f32 v213, v213
  ds_read_b64_tr_b16 v[64:65], v19 offset:49152
  v_mfma_f32_16x16x32_bf16 v[80:83], v[40:43], v[136:139], v[80:83]
  v_cvt_pk_bf16_f32 v142, v208, v209
  v_cvt_pk_bf16_f32 v143, v210, v211
  ds_read_b64_tr_b16 v[66:67], v19 offset:53248
  s_waitcnt lgkmcnt(8)
  v_mfma_f32_16x16x32_bf16 v[84:87], v[44:47], v[132:135], v[84:87]
  v_exp_f32 v214, v214
  v_mfma_f32_16x16x32_bf16 v[88:91], v[44:47], v[136:139], v[88:91]
  v_add_f32 v150, v150, v212
  v_add_f32 v151, v151, v213
  ds_read_b128 v[36:39], v20 offset:8192
  v_mfma_f32_16x16x32_bf16 v[92:95], v[48:51], v[132:135], v[92:95]
  v_exp_f32 v215, v215
  v_mfma_f32_16x16x32_bf16 v[96:99], v[48:51], v[136:139], v[96:99]
  s_add_u32 s62, s46, 90112
  s_add_u32 m0, s45, 90112
  ds_read_b128 v[40:43], v21 offset:8192
  buffer_load_dwordx4 v9, s[24:27], s62 offen lds
  s_waitcnt lgkmcnt(6)
  v_mfma_f32_16x16x32_bf16 v[100:103], v[52:55], v[132:135], v[100:103]
  v_exp_f32 v216, v216
  v_mfma_f32_16x16x32_bf16 v[104:107], v[52:55], v[136:139], v[104:107]
  v_add_f32 v150, v150, v214
  v_add_f32 v151, v151, v215
  ds_read_b128 v[44:47], v22 offset:8192
  v_mfma_f32_16x16x32_bf16 v[108:111], v[56:59], v[132:135], v[108:111]
  v_exp_f32 v217, v217
  v_mfma_f32_16x16x32_bf16 v[112:115], v[56:59], v[136:139], v[112:115]
  v_cvt_pk_bf16_f32 v144, v212, v213
  v_cvt_pk_bf16_f32 v145, v214, v215
  ds_read_b128 v[48:51], v23 offset:8192
  buffer_store_dwordx4 v[244:247], v27, s[28:31], s50 offen sc1
  s_waitcnt lgkmcnt(4)
  v_mfma_f32_16x16x32_bf16 v[116:119], v[60:63], v[132:135], v[116:119]
  v_exp_f32 v218, v218
  v_mfma_f32_16x16x32_bf16 v[120:123], v[60:63], v[136:139], v[120:123]
  v_add_f32 v150, v150, v216
  v_add_f32 v151, v151, v217
  ds_read_b128 v[52:55], v20 offset:12288
  v_mfma_f32_16x16x32_bf16 v[124:127], v[64:67], v[132:135], v[124:127]
  v_exp_f32 v219, v219
  v_mfma_f32_16x16x32_bf16 v[128:131], v[64:67], v[136:139], v[128:131]
  s_add_u32 s43, s43, 8192
  ds_read_b128 v[56:59], v21 offset:12288
  s_waitcnt lgkmcnt(4)
  v_mfma_f32_16x16x32_bf16 v[204:207], v[36:39], v[156:159], 0
  v_exp_f32 v188, v188
  v_mfma_f32_16x16x32_bf16 v[212:215], v[36:39], v[172:175], 0
  v_add_f32 v150, v150, v218
  v_add_f32 v151, v151, v219
  ds_read_b128 v[60:63], v22 offset:12288
  v_mfma_f32_16x16x32_bf16 v[204:207], v[40:43], v[160:163], v[204:207]
  v_exp_f32 v189, v189
  v_mfma_f32_16x16x32_bf16 v[212:215], v[40:43], v[176:179], v[212:215]
  v_cvt_pk_bf16_f32 v146, v216, v217
  v_cvt_pk_bf16_f32 v147, v218, v219
  ds_read_b128 v[64:67], v23 offset:12288
  s_waitcnt lgkmcnt(4)
  v_mfma_f32_16x16x32_bf16 v[204:207], v[44:47], v[164:167], v[204:207]
  v_exp_f32 v190, v190
  ds_read_b64_tr_b16 v[36:37], v12 offset:57344
  v_mfma_f32_16x16x32_bf16 v[212:215], v[44:47], v[180:183], v[212:215]
  v_add_f32 v148, v148, v188
  v_add_f32 v149, v149, v189
  ds_read_b64_tr_b16 v[38:39], v12 offset:61440
  v_mfma_f32_16x16x32_bf16 v[204:207], v[48:51], v[168:171], v[204:207]
  v_exp_f32 v191, v191
  ds_read_b64_tr_b16 v[40:41], v13 offset:57344
  v_mfma_f32_16x16x32_bf16 v[212:215], v[48:51], v[184:187], v[212:215]
  s_add_u32 s62, s46, 114688
  s_add_u32 m0, s45, 49152
  ds_read_b64_tr_b16 v[42:43], v13 offset:61440
  buffer_load_dwordx4 v8, s[20:23], s62 offen lds
  s_waitcnt lgkmcnt(6)
  v_mfma_f32_16x16x32_bf16 v[208:211], v[52:55], v[156:159], 0
  v_exp_f32 v192, v192
  ds_read_b64_tr_b16 v[44:45], v14 offset:57344
  v_mfma_f32_16x16x32_bf16 v[216:219], v[52:55], v[172:175], 0
  v_add_f32 v148, v148, v190
  v_add_f32 v149, v149, v191
  ds_read_b64_tr_b16 v[46:47], v14 offset:61440
  v_mfma_f32_16x16x32_bf16 v[208:211], v[56:59], v[160:163], v[208:211]
  v_exp_f32 v193, v193
  ds_read_b64_tr_b16 v[48:49], v15 offset:57344
  v_mfma_f32_16x16x32_bf16 v[216:219], v[56:59], v[176:179], v[216:219]
  v_cvt_pk_bf16_f32 v132, v188, v189
  v_cvt_pk_bf16_f32 v133, v190, v191
  ds_read_b64_tr_b16 v[50:51], v15 offset:61440
  s_waitcnt lgkmcnt(8)
  v_mfma_f32_16x16x32_bf16 v[208:211], v[60:63], v[164:167], v[208:211]
  v_exp_f32 v194, v194
  ds_read_b64_tr_b16 v[52:53], v16 offset:57344
  v_mfma_f32_16x16x32_bf16 v[216:219], v[60:63], v[180:183], v[216:219]
  v_add_f32 v148, v148, v192
  v_add_f32 v149, v149, v193
  ds_read_b64_tr_b16 v[54:55], v16 offset:61440
  v_mfma_f32_16x16x32_bf16 v[208:211], v[64:67], v[168:171], v[208:211]
  v_exp_f32 v195, v195
  ds_read_b64_tr_b16 v[56:57], v17 offset:57344
  v_mfma_f32_16x16x32_bf16 v[216:219], v[64:67], v[184:187], v[216:219]
  ds_read_b64_tr_b16 v[58:59], v17 offset:61440
  s_waitcnt lgkmcnt(8)
  v_mfma_f32_16x16x32_bf16 v[68:71], v[36:39], v[140:143], v[68:71]
  v_exp_f32 v196, v196
  ds_read_b64_tr_b16 v[60:61], v18 offset:57344
  v_mfma_f32_16x16x32_bf16 v[72:75], v[36:39], v[144:147], v[72:75]
  v_add_f32 v148, v148, v194
  v_add_f32 v149, v149, v195
  ds_read_b64_tr_b16 v[62:63], v18 offset:61440
  v_mfma_f32_16x16x32_bf16 v[76:79], v[40:43], v[140:143], v[76:79]
  v_exp_f32 v197, v197
  ds_read_b64_tr_b16 v[64:65], v19 offset:57344
  v_mfma_f32_16x16x32_bf16 v[80:83], v[40:43], v[144:147], v[80:83]
  v_cvt_pk_bf16_f32 v134, v192, v193
  v_cvt_pk_bf16_f32 v135, v194, v195
  ds_read_b64_tr_b16 v[66:67], v19 offset:61440
  s_waitcnt lgkmcnt(8)
  v_mfma_f32_16x16x32_bf16 v[84:87], v[44:47], v[140:143], v[84:87]
  v_exp_f32 v198, v198
  v_mfma_f32_16x16x32_bf16 v[88:91], v[44:47], v[144:147], v[88:91]
  s_waitcnt vmcnt(9)
  s_barrier
  v_add_f32 v150, v150, v196
  v_add_f32 v151, v151, v197
  ds_read_b128 v[36:39], v20 offset:16384
  v_mfma_f32_16x16x32_bf16 v[92:95], v[48:51], v[140:143], v[92:95]
  v_exp_f32 v199, v199
  v_mfma_f32_16x16x32_bf16 v[96:99], v[48:51], v[144:147], v[96:99]
  s_add_u32 s62, s46, 98304
  s_add_u32 m0, s45, 98304
  ds_read_b128 v[40:43], v21 offset:16384
  buffer_load_dwordx4 v9, s[24:27], s62 offen lds
  s_waitcnt lgkmcnt(6)
  v_mfma_f32_16x16x32_bf16 v[100:103], v[52:55], v[140:143], v[100:103]
  v_exp_f32 v200, v200
  v_mfma_f32_16x16x32_bf16 v[104:107], v[52:55], v[144:147], v[104:107]
  v_add_f32 v150, v150, v198
  v_add_f32 v151, v151, v199
  ds_read_b128 v[44:47], v22 offset:16384
  v_mfma_f32_16x16x32_bf16 v[108:111], v[56:59], v[140:143], v[108:111]
  v_exp_f32 v201, v201
  v_mfma_f32_16x16x32_bf16 v[112:115], v[56:59], v[144:147], v[112:115]
  v_cvt_pk_bf16_f32 v136, v196, v197
  v_cvt_pk_bf16_f32 v137, v198, v199
  ds_read_b128 v[48:51], v23 offset:16384
  s_waitcnt lgkmcnt(4)
  v_mfma_f32_16x16x32_bf16 v[116:119], v[60:63], v[140:143], v[116:119]
  v_exp_f32 v202, v202
  v_mfma_f32_16x16x32_bf16 v[120:123], v[60:63], v[144:147], v[120:123]
  v_add_f32 v150, v150, v200
  v_add_f32 v151, v151, v201
  ds_read_b128 v[52:55], v20 offset:20480
  v_mfma_f32_16x16x32_bf16 v[124:127], v[64:67], v[140:143], v[124:127]
  v_exp_f32 v203, v203
  v_mfma_f32_16x16x32_bf16 v[128:131], v[64:67], v[144:147], v[128:131]
  ds_read_b128 v[56:59], v21 offset:20480
  s_waitcnt lgkmcnt(4)
  v_mfma_f32_16x16x32_bf16 v[188:191], v[36:39], v[156:159], 0
  v_exp_f32 v204, v204
  v_mfma_f32_16x16x32_bf16 v[196:199], v[36:39], v[172:175], 0
  v_add_f32 v150, v150, v202
  v_add_f32 v151, v151, v203
  ds_read_b128 v[60:63], v22 offset:20480
  v_mfma_f32_16x16x32_bf16 v[188:191], v[40:43], v[160:163], v[188:191]
  v_exp_f32 v205, v205
  v_mfma_f32_16x16x32_bf16 v[196:199], v[40:43], v[176:179], v[196:199]
  v_cvt_pk_bf16_f32 v138, v200, v201
  v_cvt_pk_bf16_f32 v139, v202, v203
  ds_read_b128 v[64:67], v23 offset:20480
  s_waitcnt lgkmcnt(4)
  v_mfma_f32_16x16x32_bf16 v[188:191], v[44:47], v[164:167], v[188:191]
  v_exp_f32 v206, v206
  ds_read_b64_tr_b16 v[36:37], v12 offset:0
  v_mfma_f32_16x16x32_bf16 v[196:199], v[44:47], v[180:183], v[196:199]
  v_add_f32 v148, v148, v204
  v_add_f32 v149, v149, v205
  ds_read_b64_tr_b16 v[38:39], v12 offset:4096
  v_mfma_f32_16x16x32_bf16 v[188:191], v[48:51], v[168:171], v[188:191]
  v_exp_f32 v207, v207
  ds_read_b64_tr_b16 v[40:41], v13 offset:0
  v_mfma_f32_16x16x32_bf16 v[196:199], v[48:51], v[184:187], v[196:199]
  s_add_u32 s62, s46, 122880
  s_add_u32 m0, s45, 57344
  ds_read_b64_tr_b16 v[42:43], v13 offset:4096
  buffer_load_dwordx4 v8, s[20:23], s62 offen lds
  s_waitcnt lgkmcnt(6)
  v_mfma_f32_16x16x32_bf16 v[192:195], v[52:55], v[156:159], 0
  v_exp_f32 v208, v208
  ds_read_b64_tr_b16 v[44:45], v14 offset:0
  v_mfma_f32_16x16x32_bf16 v[200:203], v[52:55], v[172:175], 0
  v_add_f32 v148, v148, v206
  v_add_f32 v149, v149, v207
  ds_read_b64_tr_b16 v[46:47], v14 offset:4096
  v_mfma_f32_16x16x32_bf16 v[192:195], v[56:59], v[160:163], v[192:195]
  v_exp_f32 v209, v209
  ds_read_b64_tr_b16 v[48:49], v15 offset:0
  v_mfma_f32_16x16x32_bf16 v[200:203], v[56:59], v[176:179], v[200:203]
  v_cvt_pk_bf16_f32 v140, v204, v205
  v_cvt_pk_bf16_f32 v141, v206, v207
  ds_read_b64_tr_b16 v[50:51], v15 offset:4096
  s_waitcnt lgkmcnt(8)
  v_mfma_f32_16x16x32_bf16 v[192:195], v[60:63], v[164:167], v[192:195]
  v_exp_f32 v210, v210
  ds_read_b64_tr_b16 v[52:53], v16 offset:0
  v_mfma_f32_16x16x32_bf16 v[200:203], v[60:63], v[180:183], v[200:203]
  v_add_f32 v148, v148, v208
  v_add_f32 v149, v149, v209
  ds_read_b64_tr_b16 v[54:55], v16 offset:4096
  v_mfma_f32_16x16x32_bf16 v[192:195], v[64:67], v[168:171], v[192:195]
  v_exp_f32 v211, v211
  ds_read_b64_tr_b16 v[56:57], v17 offset:0
  v_mfma_f32_16x16x32_bf16 v[200:203], v[64:67], v[184:187], v[200:203]
  ds_read_b64_tr_b16 v[58:59], v17 offset:4096
  buffer_load_dword v252, v253, s[12:15], s43 offen
  s_waitcnt lgkmcnt(8)
  v_mfma_f32_16x16x32_bf16 v[68:71], v[36:39], v[132:135], v[68:71]
  v_exp_f32 v212, v212
  ds_read_b64_tr_b16 v[60:61], v18 offset:0
  v_mfma_f32_16x16x32_bf16 v[72:75], v[36:39], v[136:139], v[72:75]
  v_add_f32 v148, v148, v210
  v_add_f32 v149, v149, v211
  ds_read_b64_tr_b16 v[62:63], v18 offset:4096
  v_mfma_f32_16x16x32_bf16 v[76:79], v[40:43], v[132:135], v[76:79]
  v_exp_f32 v213, v213
  ds_read_b64_tr_b16 v[64:65], v19 offset:0
  v_mfma_f32_16x16x32_bf16 v[80:83], v[40:43], v[136:139], v[80:83]
  v_cvt_pk_bf16_f32 v142, v208, v209
  v_cvt_pk_bf16_f32 v143, v210, v211
  ds_read_b64_tr_b16 v[66:67], v19 offset:4096
  s_waitcnt lgkmcnt(8)
  v_mfma_f32_16x16x32_bf16 v[84:87], v[44:47], v[132:135], v[84:87]
  v_exp_f32 v214, v214
  v_mfma_f32_16x16x32_bf16 v[88:91], v[44:47], v[136:139], v[88:91]
  v_add_f32 v150, v150, v212
  v_add_f32 v151, v151, v213
  ds_read_b128 v[36:39], v20 offset:24576
  v_mfma_f32_16x16x32_bf16 v[92:95], v[48:51], v[132:135], v[92:95]
  v_exp_f32 v215, v215
  v_mfma_f32_16x16x32_bf16 v[96:99], v[48:51], v[136:139], v[96:99]
  s_add_u32 s62, s46, 106496
  s_add_u32 m0, s45, 106496
  ds_read_b128 v[40:43], v21 offset:24576
  buffer_load_dwordx4 v9, s[24:27], s62 offen lds
  s_waitcnt lgkmcnt(6)
  v_mfma_f32_16x16x32_bf16 v[100:103], v[52:55], v[132:135], v[100:103]
  v_exp_f32 v216, v216
  v_mfma_f32_16x16x32_bf16 v[104:107], v[52:55], v[136:139], v[104:107]
  v_add_f32 v150, v150, v214
  v_add_f32 v151, v151, v215
  ds_read_b128 v[44:47], v22 offset:24576
  v_mfma_f32_16x16x32_bf16 v[108:111], v[56:59], v[132:135], v[108:111]
  v_exp_f32 v217, v217
  v_mfma_f32_16x16x32_bf16 v[112:115], v[56:59], v[136:139], v[112:115]
  v_cvt_pk_bf16_f32 v144, v212, v213
  v_cvt_pk_bf16_f32 v145, v214, v215
  ds_read_b128 v[48:51], v23 offset:24576
  s_waitcnt lgkmcnt(4)
  v_mfma_f32_16x16x32_bf16 v[116:119], v[60:63], v[132:135], v[116:119]
  v_exp_f32 v218, v218
  v_mfma_f32_16x16x32_bf16 v[120:123], v[60:63], v[136:139], v[120:123]
  v_add_f32 v150, v150, v216
  v_add_f32 v151, v151, v217
  ds_read_b128 v[52:55], v20 offset:28672
  v_mfma_f32_16x16x32_bf16 v[124:127], v[64:67], v[132:135], v[124:127]
  v_exp_f32 v219, v219
  v_mfma_f32_16x16x32_bf16 v[128:131], v[64:67], v[136:139], v[128:131]
  s_add_u32 s43, s43, 8192
  ds_read_b128 v[56:59], v21 offset:28672
  buffer_store_dwordx4 v[248:251], v27, s[28:31], s78 offen sc1
  s_waitcnt lgkmcnt(4)
  v_mfma_f32_16x16x32_bf16 v[204:207], v[36:39], v[156:159], 0
  v_exp_f32 v188, v188
  v_mfma_f32_16x16x32_bf16 v[212:215], v[36:39], v[172:175], 0
  v_add_f32 v150, v150, v218
  v_add_f32 v151, v151, v219
  ds_read_b128 v[60:63], v22 offset:28672
  v_mfma_f32_16x16x32_bf16 v[204:207], v[40:43], v[160:163], v[204:207]
  v_exp_f32 v189, v189
  v_mfma_f32_16x16x32_bf16 v[212:215], v[40:43], v[176:179], v[212:215]
  v_cvt_pk_bf16_f32 v146, v216, v217
  v_cvt_pk_bf16_f32 v147, v218, v219
  ds_read_b128 v[64:67], v23 offset:28672
  s_waitcnt lgkmcnt(4)
  v_mfma_f32_16x16x32_bf16 v[204:207], v[44:47], v[164:167], v[204:207]
  v_exp_f32 v190, v190
  ds_read_b64_tr_b16 v[36:37], v12 offset:8192
  v_mfma_f32_16x16x32_bf16 v[212:215], v[44:47], v[180:183], v[212:215]
  v_add_f32 v148, v148, v188
  v_add_f32 v149, v149, v189
  ds_read_b64_tr_b16 v[38:39], v12 offset:12288
  v_mfma_f32_16x16x32_bf16 v[204:207], v[48:51], v[168:171], v[204:207]
  v_exp_f32 v191, v191
  ds_read_b64_tr_b16 v[40:41], v13 offset:8192
  v_mfma_f32_16x16x32_bf16 v[212:215], v[48:51], v[184:187], v[212:215]
  s_add_u32 s62, s46, 114688
  s_add_u32 m0, s45, 114688
  ds_read_b64_tr_b16 v[42:43], v13 offset:12288
  buffer_load_dwordx4 v9, s[24:27], s62 offen lds
  s_waitcnt lgkmcnt(6)
  v_mfma_f32_16x16x32_bf16 v[208:211], v[52:55], v[156:159], 0
  v_exp_f32 v192, v192
  ds_read_b64_tr_b16 v[44:45], v14 offset:8192
  v_mfma_f32_16x16x32_bf16 v[216:219], v[52:55], v[172:175], 0
  v_add_f32 v148, v148, v190
  v_add_f32 v149, v149, v191
  ds_read_b64_tr_b16 v[46:47], v14 offset:12288
  v_mfma_f32_16x16x32_bf16 v[208:211], v[56:59], v[160:163], v[208:211]
  v_exp_f32 v193, v193
  ds_read_b64_tr_b16 v[48:49], v15 offset:8192
  v_mfma_f32_16x16x32_bf16 v[216:219], v[56:59], v[176:179], v[216:219]
  v_cvt_pk_bf16_f32 v132, v188, v189
  v_cvt_pk_bf16_f32 v133, v190, v191
  ds_read_b64_tr_b16 v[50:51], v15 offset:12288
  s_waitcnt lgkmcnt(8)
  v_mfma_f32_16x16x32_bf16 v[208:211], v[60:63], v[164:167], v[208:211]
  v_exp_f32 v194, v194
  ds_read_b64_tr_b16 v[52:53], v16 offset:8192
  v_mfma_f32_16x16x32_bf16 v[216:219], v[60:63], v[180:183], v[216:219]
  v_add_f32 v148, v148, v192
  v_add_f32 v149, v149, v193
  ds_read_b64_tr_b16 v[54:55], v16 offset:12288
  v_mfma_f32_16x16x32_bf16 v[208:211], v[64:67], v[168:171], v[208:211]
  v_exp_f32 v195, v195
  ds_read_b64_tr_b16 v[56:57], v17 offset:8192
  v_mfma_f32_16x16x32_bf16 v[216:219], v[64:67], v[184:187], v[216:219]
  ds_read_b64_tr_b16 v[58:59], v17 offset:12288
  s_waitcnt lgkmcnt(8)
  v_mfma_f32_16x16x32_bf16 v[68:71], v[36:39], v[140:143], v[68:71]
  v_exp_f32 v196, v196
  ds_read_b64_tr_b16 v[60:61], v18 offset:8192
  v_mfma_f32_16x16x32_bf16 v[72:75], v[36:39], v[144:147], v[72:75]
  v_add_f32 v148, v148, v194
  v_add_f32 v149, v149, v195
  ds_read_b64_tr_b16 v[62:63], v18 offset:12288
  v_mfma_f32_16x16x32_bf16 v[76:79], v[40:43], v[140:143], v[76:79]
  v_exp_f32 v197, v197
  ds_read_b64_tr_b16 v[64:65], v19 offset:8192
  v_mfma_f32_16x16x32_bf16 v[80:83], v[40:43], v[144:147], v[80:83]
  v_cvt_pk_bf16_f32 v134, v192, v193
  v_cvt_pk_bf16_f32 v135, v194, v195
  ds_read_b64_tr_b16 v[66:67], v19 offset:12288
  s_waitcnt lgkmcnt(8)
  v_mfma_f32_16x16x32_bf16 v[84:87], v[44:47], v[140:143], v[84:87]
  v_exp_f32 v198, v198
  v_mfma_f32_16x16x32_bf16 v[88:91], v[44:47], v[144:147], v[88:91]
  s_waitcnt vmcnt(8)
  s_barrier
  v_add_f32 v150, v150, v196
  v_add_f32 v151, v151, v197
  ds_read_b128 v[36:39], v20 offset:32768
  v_mfma_f32_16x16x32_bf16 v[92:95], v[48:51], v[140:143], v[92:95]
  v_exp_f32 v199, v199
  v_mfma_f32_16x16x32_bf16 v[96:99], v[48:51], v[144:147], v[96:99]
  ds_read_b128 v[40:43], v21 offset:32768
  s_waitcnt lgkmcnt(6)
  v_mfma_f32_16x16x32_bf16 v[100:103], v[52:55], v[140:143], v[100:103]
  v_exp_f32 v200, v200
  v_mfma_f32_16x16x32_bf16 v[104:107], v[52:55], v[144:147], v[104:107]
  v_add_f32 v150, v150, v198
  v_add_f32 v151, v151, v199
  ds_read_b128 v[44:47], v22 offset:32768
  v_mfma_f32_16x16x32_bf16 v[108:111], v[56:59], v[140:143], v[108:111]
  v_exp_f32 v201, v201
  v_mfma_f32_16x16x32_bf16 v[112:115], v[56:59], v[144:147], v[112:115]
  v_cvt_pk_bf16_f32 v136, v196, v197
  v_cvt_pk_bf16_f32 v137, v198, v199
  ds_read_b128 v[48:51], v23 offset:32768
  s_waitcnt lgkmcnt(4)
  v_mfma_f32_16x16x32_bf16 v[116:119], v[60:63], v[140:143], v[116:119]
  v_exp_f32 v202, v202
  v_mfma_f32_16x16x32_bf16 v[120:123], v[60:63], v[144:147], v[120:123]
  v_add_f32 v150, v150, v200
  v_add_f32 v151, v151, v201
  ds_read_b128 v[52:55], v20 offset:36864
  v_mfma_f32_16x16x32_bf16 v[124:127], v[64:67], v[140:143], v[124:127]
  v_exp_f32 v203, v203
  v_mfma_f32_16x16x32_bf16 v[128:131], v[64:67], v[144:147], v[128:131]
  ds_read_b128 v[56:59], v21 offset:36864
  buffer_store_dwordx4 v[248:251], v27, s[28:31], s79 offen sc1
  s_waitcnt lgkmcnt(4)
  v_mfma_f32_16x16x32_bf16 v[188:191], v[36:39], v[156:159], 0
  v_exp_f32 v204, v204
  v_mfma_f32_16x16x32_bf16 v[196:199], v[36:39], v[172:175], 0
  v_add_f32 v150, v150, v202
  v_add_f32 v151, v151, v203
  ds_read_b128 v[60:63], v22 offset:36864
  v_mfma_f32_16x16x32_bf16 v[188:191], v[40:43], v[160:163], v[188:191]
  v_exp_f32 v205, v205
  v_mfma_f32_16x16x32_bf16 v[196:199], v[40:43], v[176:179], v[196:199]
  v_cvt_pk_bf16_f32 v138, v200, v201
  v_cvt_pk_bf16_f32 v139, v202, v203
  ds_read_b128 v[64:67], v23 offset:36864
  s_waitcnt lgkmcnt(4)
  v_mfma_f32_16x16x32_bf16 v[188:191], v[44:47], v[164:167], v[188:191]
  v_exp_f32 v206, v206
  ds_read_b64_tr_b16 v[36:37], v12 offset:16384
  v_mfma_f32_16x16x32_bf16 v[196:199], v[44:47], v[180:183], v[196:199]
  v_add_f32 v148, v148, v204
  v_add_f32 v149, v149, v205
  ds_read_b64_tr_b16 v[38:39], v12 offset:20480
  v_mfma_f32_16x16x32_bf16 v[188:191], v[48:51], v[168:171], v[188:191]
  v_exp_f32 v207, v207
  ds_read_b64_tr_b16 v[40:41], v13 offset:16384
  v_mfma_f32_16x16x32_bf16 v[196:199], v[48:51], v[184:187], v[196:199]
  s_add_u32 s62, s46, 122880
  s_add_u32 m0, s45, 122880
  ds_read_b64_tr_b16 v[42:43], v13 offset:20480
  buffer_load_dwordx4 v9, s[24:27], s62 offen lds
  s_waitcnt lgkmcnt(6)
  v_mfma_f32_16x16x32_bf16 v[192:195], v[52:55], v[156:159], 0
  v_exp_f32 v208, v208
  ds_read_b64_tr_b16 v[44:45], v14 offset:16384
  v_mfma_f32_16x16x32_bf16 v[200:203], v[52:55], v[172:175], 0
  v_add_f32 v148, v148, v206
  v_add_f32 v149, v149, v207
  ds_read_b64_tr_b16 v[46:47], v14 offset:20480
  v_mfma_f32_16x16x32_bf16 v[192:195], v[56:59], v[160:163], v[192:195]
  v_exp_f32 v209, v209
  ds_read_b64_tr_b16 v[48:49], v15 offset:16384
  v_mfma_f32_16x16x32_bf16 v[200:203], v[56:59], v[176:179], v[200:203]
  v_cvt_pk_bf16_f32 v140, v204, v205
  v_cvt_pk_bf16_f32 v141, v206, v207
  ds_read_b64_tr_b16 v[50:51], v15 offset:20480
  s_waitcnt lgkmcnt(8)
  v_mfma_f32_16x16x32_bf16 v[192:195], v[60:63], v[164:167], v[192:195]
  v_exp_f32 v210, v210
  ds_read_b64_tr_b16 v[52:53], v16 offset:16384
  v_mfma_f32_16x16x32_bf16 v[200:203], v[60:63], v[180:183], v[200:203]
  v_add_f32 v148, v148, v208
  v_add_f32 v149, v149, v209
  ds_read_b64_tr_b16 v[54:55], v16 offset:20480
  v_mfma_f32_16x16x32_bf16 v[192:195], v[64:67], v[168:171], v[192:195]
  v_exp_f32 v211, v211
  ds_read_b64_tr_b16 v[56:57], v17 offset:16384
  v_mfma_f32_16x16x32_bf16 v[200:203], v[64:67], v[184:187], v[200:203]
  ds_read_b64_tr_b16 v[58:59], v17 offset:20480
  buffer_load_dword v252, v253, s[12:15], s43 offen
  s_waitcnt lgkmcnt(8)
  v_mfma_f32_16x16x32_bf16 v[68:71], v[36:39], v[132:135], v[68:71]
  v_exp_f32 v212, v212
  ds_read_b64_tr_b16 v[60:61], v18 offset:16384
  v_mfma_f32_16x16x32_bf16 v[72:75], v[36:39], v[136:139], v[72:75]
  v_add_f32 v148, v148, v210
  v_add_f32 v149, v149, v211
  ds_read_b64_tr_b16 v[62:63], v18 offset:20480
  v_mfma_f32_16x16x32_bf16 v[76:79], v[40:43], v[132:135], v[76:79]
  v_exp_f32 v213, v213
  ds_read_b64_tr_b16 v[64:65], v19 offset:16384
  v_mfma_f32_16x16x32_bf16 v[80:83], v[40:43], v[136:139], v[80:83]
  v_cvt_pk_bf16_f32 v142, v208, v209
  v_cvt_pk_bf16_f32 v143, v210, v211
  ds_read_b64_tr_b16 v[66:67], v19 offset:20480
  s_waitcnt lgkmcnt(8)
  v_mfma_f32_16x16x32_bf16 v[84:87], v[44:47], v[132:135], v[84:87]
  v_exp_f32 v214, v214
  v_mfma_f32_16x16x32_bf16 v[88:91], v[44:47], v[136:139], v[88:91]
  v_add_f32 v150, v150, v212
  v_add_f32 v151, v151, v213
  ds_read_b128 v[36:39], v20 offset:40960
  v_mfma_f32_16x16x32_bf16 v[92:95], v[48:51], v[132:135], v[92:95]
  v_exp_f32 v215, v215
  v_mfma_f32_16x16x32_bf16 v[96:99], v[48:51], v[136:139], v[96:99]
  ds_read_b128 v[40:43], v21 offset:40960
  s_waitcnt lgkmcnt(6)
  v_mfma_f32_16x16x32_bf16 v[100:103], v[52:55], v[132:135], v[100:103]
  v_exp_f32 v216, v216
  v_mfma_f32_16x16x32_bf16 v[104:107], v[52:55], v[136:139], v[104:107]
  v_add_f32 v150, v150, v214
  v_add_f32 v151, v151, v215
  ds_read_b128 v[44:47], v22 offset:40960
  v_mfma_f32_16x16x32_bf16 v[108:111], v[56:59], v[132:135], v[108:111]
  v_exp_f32 v217, v217
  v_mfma_f32_16x16x32_bf16 v[112:115], v[56:59], v[136:139], v[112:115]
  v_cvt_pk_bf16_f32 v144, v212, v213
  v_cvt_pk_bf16_f32 v145, v214, v215
  ds_read_b128 v[48:51], v23 offset:40960
  s_waitcnt lgkmcnt(4)
  v_mfma_f32_16x16x32_bf16 v[116:119], v[60:63], v[132:135], v[116:119]
  v_exp_f32 v218, v218
  v_mfma_f32_16x16x32_bf16 v[120:123], v[60:63], v[136:139], v[120:123]
  v_add_f32 v150, v150, v216
  v_add_f32 v151, v151, v217
  ds_read_b128 v[52:55], v20 offset:45056
  v_mfma_f32_16x16x32_bf16 v[124:127], v[64:67], v[132:135], v[124:127]
  v_exp_f32 v219, v219
  v_mfma_f32_16x16x32_bf16 v[128:131], v[64:67], v[136:139], v[128:131]
  s_add_u32 s43, s43, 8192
  ds_read_b128 v[56:59], v21 offset:45056
  buffer_store_dwordx4 v[248:251], v27, s[28:31], s80 offen sc1
  s_waitcnt lgkmcnt(4)
  v_mfma_f32_16x16x32_bf16 v[204:207], v[36:39], v[156:159], 0
  v_exp_f32 v188, v188
  v_mfma_f32_16x16x32_bf16 v[212:215], v[36:39], v[172:175], 0
  v_add_f32 v150, v150, v218
  v_add_f32 v151, v151, v219
  ds_read_b128 v[60:63], v22 offset:45056
  v_mfma_f32_16x16x32_bf16 v[204:207], v[40:43], v[160:163], v[204:207]
  v_exp_f32 v189, v189
  v_mfma_f32_16x16x32_bf16 v[212:215], v[40:43], v[176:179], v[212:215]
  v_cvt_pk_bf16_f32 v146, v216, v217
  v_cvt_pk_bf16_f32 v147, v218, v219
  ds_read_b128 v[64:67], v23 offset:45056
  s_waitcnt lgkmcnt(4)
  v_mfma_f32_16x16x32_bf16 v[204:207], v[44:47], v[164:167], v[204:207]
  v_exp_f32 v190, v190
  ds_read_b64_tr_b16 v[36:37], v12 offset:24576
  v_mfma_f32_16x16x32_bf16 v[212:215], v[44:47], v[180:183], v[212:215]
  v_add_f32 v148, v148, v188
  v_add_f32 v149, v149, v189
  ds_read_b64_tr_b16 v[38:39], v12 offset:28672
  v_mfma_f32_16x16x32_bf16 v[204:207], v[48:51], v[168:171], v[204:207]
  v_exp_f32 v191, v191
  ds_read_b64_tr_b16 v[40:41], v13 offset:24576
  v_mfma_f32_16x16x32_bf16 v[212:215], v[48:51], v[184:187], v[212:215]
  ds_read_b64_tr_b16 v[42:43], v13 offset:28672
  s_waitcnt lgkmcnt(6)
  v_mfma_f32_16x16x32_bf16 v[208:211], v[52:55], v[156:159], 0
  v_exp_f32 v192, v192
  ds_read_b64_tr_b16 v[44:45], v14 offset:24576
  v_mfma_f32_16x16x32_bf16 v[216:219], v[52:55], v[172:175], 0
  v_add_f32 v148, v148, v190
  v_add_f32 v149, v149, v191
  ds_read_b64_tr_b16 v[46:47], v14 offset:28672
  v_mfma_f32_16x16x32_bf16 v[208:211], v[56:59], v[160:163], v[208:211]
  v_exp_f32 v193, v193
  ds_read_b64_tr_b16 v[48:49], v15 offset:24576
  v_mfma_f32_16x16x32_bf16 v[216:219], v[56:59], v[176:179], v[216:219]
  v_cvt_pk_bf16_f32 v132, v188, v189
  v_cvt_pk_bf16_f32 v133, v190, v191
  ds_read_b64_tr_b16 v[50:51], v15 offset:28672
  s_waitcnt lgkmcnt(8)
  v_mfma_f32_16x16x32_bf16 v[208:211], v[60:63], v[164:167], v[208:211]
  v_exp_f32 v194, v194
  ds_read_b64_tr_b16 v[52:53], v16 offset:24576
  v_mfma_f32_16x16x32_bf16 v[216:219], v[60:63], v[180:183], v[216:219]
  v_add_f32 v148, v148, v192
  v_add_f32 v149, v149, v193
  ds_read_b64_tr_b16 v[54:55], v16 offset:28672
  v_mfma_f32_16x16x32_bf16 v[208:211], v[64:67], v[168:171], v[208:211]
  v_exp_f32 v195, v195
  ds_read_b64_tr_b16 v[56:57], v17 offset:24576
  v_mfma_f32_16x16x32_bf16 v[216:219], v[64:67], v[184:187], v[216:219]
  ds_read_b64_tr_b16 v[58:59], v17 offset:28672
  s_waitcnt lgkmcnt(8)
  v_mfma_f32_16x16x32_bf16 v[68:71], v[36:39], v[140:143], v[68:71]
  v_exp_f32 v196, v196
  ds_read_b64_tr_b16 v[60:61], v18 offset:24576
  v_mfma_f32_16x16x32_bf16 v[72:75], v[36:39], v[144:147], v[72:75]
  v_add_f32 v148, v148, v194
  v_add_f32 v149, v149, v195
  ds_read_b64_tr_b16 v[62:63], v18 offset:28672
  v_mfma_f32_16x16x32_bf16 v[76:79], v[40:43], v[140:143], v[76:79]
  v_exp_f32 v197, v197
  ds_read_b64_tr_b16 v[64:65], v19 offset:24576
  v_mfma_f32_16x16x32_bf16 v[80:83], v[40:43], v[144:147], v[80:83]
  v_cvt_pk_bf16_f32 v134, v192, v193
  v_cvt_pk_bf16_f32 v135, v194, v195
  ds_read_b64_tr_b16 v[66:67], v19 offset:28672
  s_waitcnt lgkmcnt(8)
  v_mfma_f32_16x16x32_bf16 v[84:87], v[44:47], v[140:143], v[84:87]
  v_exp_f32 v198, v198
  v_mfma_f32_16x16x32_bf16 v[88:91], v[44:47], v[144:147], v[88:91]
  s_waitcnt vmcnt(2)
  s_barrier
  v_add_f32 v150, v150, v196
  v_add_f32 v151, v151, v197
  ds_read_b128 v[36:39], v20 offset:49152
  v_mfma_f32_16x16x32_bf16 v[92:95], v[48:51], v[140:143], v[92:95]
  v_exp_f32 v199, v199
  v_mfma_f32_16x16x32_bf16 v[96:99], v[48:51], v[144:147], v[96:99]
  s_add_u32 s62, s89, 0
  s_add_u32 m0, s45, 0
  ds_read_b128 v[40:43], v21 offset:49152
  buffer_load_dwordx4 v2, s[12:15], s62 offen lds
  s_waitcnt lgkmcnt(6)
  v_mfma_f32_16x16x32_bf16 v[100:103], v[52:55], v[140:143], v[100:103]
  v_exp_f32 v200, v200
  v_mfma_f32_16x16x32_bf16 v[104:107], v[52:55], v[144:147], v[104:107]
  v_add_f32 v150, v150, v198
  v_add_f32 v151, v151, v199
  ds_read_b128 v[44:47], v22 offset:49152
  v_mfma_f32_16x16x32_bf16 v[108:111], v[56:59], v[140:143], v[108:111]
  v_exp_f32 v201, v201
  v_mfma_f32_16x16x32_bf16 v[112:115], v[56:59], v[144:147], v[112:115]
  v_cvt_pk_bf16_f32 v136, v196, v197
  v_cvt_pk_bf16_f32 v137, v198, v199
  s_add_u32 s63, s89, 32768
  s_add_u32 m0, s45, 8192
  ds_read_b128 v[48:51], v23 offset:49152
  buffer_load_dwordx4 v2, s[12:15], s63 offen lds
  s_waitcnt lgkmcnt(4)
  v_mfma_f32_16x16x32_bf16 v[116:119], v[60:63], v[140:143], v[116:119]
  v_exp_f32 v202, v202
  v_mfma_f32_16x16x32_bf16 v[120:123], v[60:63], v[144:147], v[120:123]
  v_add_f32 v150, v150, v200
  v_add_f32 v151, v151, v201
  ds_read_b128 v[52:55], v20 offset:53248
  v_mfma_f32_16x16x32_bf16 v[124:127], v[64:67], v[140:143], v[124:127]
  v_exp_f32 v203, v203
  v_mfma_f32_16x16x32_bf16 v[128:131], v[64:67], v[144:147], v[128:131]
  ds_read_b128 v[56:59], v21 offset:53248
  buffer_store_dwordx4 v[248:251], v27, s[28:31], s81 offen sc1
  s_waitcnt lgkmcnt(4)
  v_mfma_f32_16x16x32_bf16 v[188:191], v[36:39], v[156:159], 0
  v_exp_f32 v204, v204
  v_mfma_f32_16x16x32_bf16 v[196:199], v[36:39], v[172:175], 0
  v_add_f32 v150, v150, v202
  v_add_f32 v151, v151, v203
  ds_read_b128 v[60:63], v22 offset:53248
  v_mfma_f32_16x16x32_bf16 v[188:191], v[40:43], v[160:163], v[188:191]
  v_exp_f32 v205, v205
  v_mfma_f32_16x16x32_bf16 v[196:199], v[40:43], v[176:179], v[196:199]
  v_cvt_pk_bf16_f32 v138, v200, v201
  v_cvt_pk_bf16_f32 v139, v202, v203
  s_add_u32 s62, s89, 65536
  s_add_u32 m0, s45, 16384
  ds_read_b128 v[64:67], v23 offset:53248
  buffer_load_dwordx4 v2, s[12:15], s62 offen lds
  s_waitcnt lgkmcnt(4)
  v_mfma_f32_16x16x32_bf16 v[188:191], v[44:47], v[164:167], v[188:191]
  v_exp_f32 v206, v206
  ds_read_b64_tr_b16 v[36:37], v12 offset:32768
  v_mfma_f32_16x16x32_bf16 v[196:199], v[44:47], v[180:183], v[196:199]
  v_add_f32 v148, v148, v204
  v_add_f32 v149, v149, v205
  ds_read_b64_tr_b16 v[38:39], v12 offset:36864
  v_mfma_f32_16x16x32_bf16 v[188:191], v[48:51], v[168:171], v[188:191]
  v_exp_f32 v207, v207
  ds_read_b64_tr_b16 v[40:41], v13 offset:32768
  v_mfma_f32_16x16x32_bf16 v[196:199], v[48:51], v[184:187], v[196:199]
  s_add_u32 s63, s89, 98304
  s_add_u32 m0, s45, 24576
  ds_read_b64_tr_b16 v[42:43], v13 offset:36864
  buffer_load_dwordx4 v2, s[12:15], s63 offen lds
  s_waitcnt lgkmcnt(6)
  v_mfma_f32_16x16x32_bf16 v[192:195], v[52:55], v[156:159], 0
  v_exp_f32 v208, v208
  ds_read_b64_tr_b16 v[44:45], v14 offset:32768
  v_mfma_f32_16x16x32_bf16 v[200:203], v[52:55], v[172:175], 0
  v_add_f32 v148, v148, v206
  v_add_f32 v149, v149, v207
  ds_read_b64_tr_b16 v[46:47], v14 offset:36864
  v_mfma_f32_16x16x32_bf16 v[192:195], v[56:59], v[160:163], v[192:195]
  v_exp_f32 v209, v209
  ds_read_b64_tr_b16 v[48:49], v15 offset:32768
  v_mfma_f32_16x16x32_bf16 v[200:203], v[56:59], v[176:179], v[200:203]
  v_cvt_pk_bf16_f32 v140, v204, v205
  v_cvt_pk_bf16_f32 v141, v206, v207
  ds_read_b64_tr_b16 v[50:51], v15 offset:36864
  s_waitcnt lgkmcnt(8)
  v_mfma_f32_16x16x32_bf16 v[192:195], v[60:63], v[164:167], v[192:195]
  v_exp_f32 v210, v210
  ds_read_b64_tr_b16 v[52:53], v16 offset:32768
  v_mfma_f32_16x16x32_bf16 v[200:203], v[60:63], v[180:183], v[200:203]
  v_add_f32 v148, v148, v208
  v_add_f32 v149, v149, v209
  ds_read_b64_tr_b16 v[54:55], v16 offset:36864
  v_mfma_f32_16x16x32_bf16 v[192:195], v[64:67], v[168:171], v[192:195]
  v_exp_f32 v211, v211
  ds_read_b64_tr_b16 v[56:57], v17 offset:32768
  v_mfma_f32_16x16x32_bf16 v[200:203], v[64:67], v[184:187], v[200:203]
  s_add_u32 s62, s89, 131072
  s_add_u32 m0, s45, 65536
  ds_read_b64_tr_b16 v[58:59], v17 offset:36864
  buffer_load_dwordx4 v2, s[12:15], s62 offen lds
  s_waitcnt lgkmcnt(8)
  v_mfma_f32_16x16x32_bf16 v[68:71], v[36:39], v[132:135], v[68:71]
  v_exp_f32 v212, v212
  ds_read_b64_tr_b16 v[60:61], v18 offset:32768
  v_mfma_f32_16x16x32_bf16 v[72:75], v[36:39], v[136:139], v[72:75]
  v_add_f32 v148, v148, v210
  v_add_f32 v149, v149, v211
  ds_read_b64_tr_b16 v[62:63], v18 offset:36864
  v_mfma_f32_16x16x32_bf16 v[76:79], v[40:43], v[132:135], v[76:79]
  v_exp_f32 v213, v213
  ds_read_b64_tr_b16 v[64:65], v19 offset:32768
  v_mfma_f32_16x16x32_bf16 v[80:83], v[40:43], v[136:139], v[80:83]
  v_cvt_pk_bf16_f32 v142, v208, v209
  v_cvt_pk_bf16_f32 v143, v210, v211
  ds_read_b64_tr_b16 v[66:67], v19 offset:36864
  s_waitcnt lgkmcnt(8)
  v_mfma_f32_16x16x32_bf16 v[84:87], v[44:47], v[132:135], v[84:87]
  v_exp_f32 v214, v214
  v_mfma_f32_16x16x32_bf16 v[88:91], v[44:47], v[136:139], v[88:91]
  v_add_f32 v150, v150, v212
  v_add_f32 v151, v151, v213
  ds_read_b128 v[36:39], v20 offset:57344
  v_mfma_f32_16x16x32_bf16 v[92:95], v[48:51], v[132:135], v[92:95]
  v_exp_f32 v215, v215
  v_mfma_f32_16x16x32_bf16 v[96:99], v[48:51], v[136:139], v[96:99]
  s_add_u32 s63, s89, 163840
  s_add_u32 m0, s45, 73728
  ds_read_b128 v[40:43], v21 offset:57344
  buffer_load_dwordx4 v2, s[12:15], s63 offen lds
  s_waitcnt lgkmcnt(6)
  v_mfma_f32_16x16x32_bf16 v[100:103], v[52:55], v[132:135], v[100:103]
  v_exp_f32 v216, v216
  v_mfma_f32_16x16x32_bf16 v[104:107], v[52:55], v[136:139], v[104:107]
  v_add_f32 v150, v150, v214
  v_add_f32 v151, v151, v215
  ds_read_b128 v[44:47], v22 offset:57344
  v_mfma_f32_16x16x32_bf16 v[108:111], v[56:59], v[132:135], v[108:111]
  v_exp_f32 v217, v217
  v_mfma_f32_16x16x32_bf16 v[112:115], v[56:59], v[136:139], v[112:115]
  v_cvt_pk_bf16_f32 v144, v212, v213
  v_cvt_pk_bf16_f32 v145, v214, v215
  ds_read_b128 v[48:51], v23 offset:57344
  s_waitcnt lgkmcnt(4)
  v_mfma_f32_16x16x32_bf16 v[116:119], v[60:63], v[132:135], v[116:119]
  v_exp_f32 v218, v218
  v_mfma_f32_16x16x32_bf16 v[120:123], v[60:63], v[136:139], v[120:123]
  v_add_f32 v150, v150, v216
  v_add_f32 v151, v151, v217
  ds_read_b128 v[52:55], v20 offset:61440
  v_mfma_f32_16x16x32_bf16 v[124:127], v[64:67], v[132:135], v[124:127]
  v_exp_f32 v219, v219
  v_mfma_f32_16x16x32_bf16 v[128:131], v[64:67], v[136:139], v[128:131]
  ds_read_b128 v[56:59], v21 offset:61440
  v_lshlrev_b32 v28, 7, v1
  s_mov_b64 exec, 0xff
  global_load_dword v252, v28, s[94:95]
  s_mov_b64 exec, -1
  s_waitcnt lgkmcnt(4)
  v_mfma_f32_16x16x32_bf16 v[204:207], v[36:39], v[156:159], 0
  v_mfma_f32_16x16x32_bf16 v[212:215], v[36:39], v[172:175], 0
  v_add_f32 v150, v150, v218
  v_add_f32 v151, v151, v219
  ds_read_b128 v[60:63], v22 offset:61440
  v_mfma_f32_16x16x32_bf16 v[204:207], v[40:43], v[160:163], v[204:207]
  v_mfma_f32_16x16x32_bf16 v[212:215], v[40:43], v[176:179], v[212:215]
  v_cvt_pk_bf16_f32 v146, v216, v217
  v_cvt_pk_bf16_f32 v147, v218, v219
  ds_read_b128 v[64:67], v23 offset:61440
  s_waitcnt lgkmcnt(4)
  v_mfma_f32_16x16x32_bf16 v[204:207], v[44:47], v[164:167], v[204:207]
  v_exp_f32 v188, v188
  v_exp_f32 v189, v189
  v_add_f32 v148, v148, v188
  v_exp_f32 v190, v190
  ds_read_b64_tr_b16 v[36:37], v12 offset:40960
  v_mfma_f32_16x16x32_bf16 v[212:215], v[44:47], v[180:183], v[212:215]
  v_add_f32 v149, v149, v189
  v_cvt_pk_bf16_f32 v132, v188, v189
  v_exp_f32 v191, v191
  v_add_f32 v148, v148, v190
  ds_read_b64_tr_b16 v[38:39], v12 offset:45056
  v_mfma_f32_16x16x32_bf16 v[204:207], v[48:51], v[168:171], v[204:207]
  v_exp_f32 v192, v192
  v_add_f32 v149, v149, v191
  v_cvt_pk_bf16_f32 v133, v190, v191
  v_exp_f32 v193, v193
  ds_read_b64_tr_b16 v[40:41], v13 offset:40960
  v_mfma_f32_16x16x32_bf16 v[212:215], v[48:51], v[184:187], v[212:215]
  v_add_f32 v148, v148, v192
  v_exp_f32 v194, v194
  v_add_f32 v149, v149, v193
  v_cvt_pk_bf16_f32 v134, v192, v193
  ds_read_b64_tr_b16 v[42:43], v13 offset:45056
  s_waitcnt lgkmcnt(6)
  v_mfma_f32_16x16x32_bf16 v[208:211], v[52:55], v[156:159], 0
  v_exp_f32 v195, v195
  v_add_f32 v148, v148, v194
  v_exp_f32 v196, v196
  v_add_f32 v149, v149, v195
  ds_read_b64_tr_b16 v[44:45], v12 offset:49152
  v_mfma_f32_16x16x32_bf16 v[216:219], v[52:55], v[172:175], 0
  v_cvt_pk_bf16_f32 v135, v194, v195
  v_exp_f32 v197, v197
  v_add_f32 v150, v150, v196
  v_exp_f32 v198, v198
  ds_read_b64_tr_b16 v[46:47], v12 offset:53248
  v_mfma_f32_16x16x32_bf16 v[208:211], v[56:59], v[160:163], v[208:211]
  v_add_f32 v151, v151, v197
  v_cvt_pk_bf16_f32 v136, v196, v197
  v_exp_f32 v199, v199
  v_add_f32 v150, v150, v198
  ds_read_b64_tr_b16 v[48:49], v13 offset:49152
  v_mfma_f32_16x16x32_bf16 v[216:219], v[56:59], v[176:179], v[216:219]
  v_exp_f32 v200, v200
  v_add_f32 v151, v151, v199
  v_cvt_pk_bf16_f32 v137, v198, v199
  v_exp_f32 v201, v201
  ds_read_b64_tr_b16 v[50:51], v13 offset:53248
  s_waitcnt lgkmcnt(8)
  v_mfma_f32_16x16x32_bf16 v[208:211], v[60:63], v[164:167], v[208:211]
  v_add_f32 v150, v150, v200
  v_exp_f32 v202, v202
  v_add_f32 v151, v151, v201
  v_cvt_pk_bf16_f32 v138, v200, v201
  ds_read_b64_tr_b16 v[52:53], v12 offset:57344
  v_mfma_f32_16x16x32_bf16 v[216:219], v[60:63], v[180:183], v[216:219]
  v_exp_f32 v203, v203
  v_add_f32 v150, v150, v202
  v_add_f32 v151, v151, v203
  v_cvt_pk_bf16_f32 v139, v202, v203
  ds_read_b64_tr_b16 v[54:55], v12 offset:61440
  v_mfma_f32_16x16x32_bf16 v[208:211], v[64:67], v[168:171], v[208:211]
  ds_read_b64_tr_b16 v[56:57], v13 offset:57344
  v_mfma_f32_16x16x32_bf16 v[216:219], v[64:67], v[184:187], v[216:219]
  ds_read_b64_tr_b16 v[58:59], v13 offset:61440
  s_mov_b32 s60, 0x53800000
  s_mov_b32 s61, 0x2b800000
  v_exp_f32 v204, v204
  v_exp_f32 v205, v205
  v_add_f32 v148, v148, v204
  v_exp_f32 v206, v206
  v_add_f32 v149, v149, v205
  v_exp_f32 v207, v207
  v_add_f32 v148, v148, v206
  v_exp_f32 v208, v208
  v_add_f32 v149, v149, v207
  v_exp_f32 v209, v209
  v_add_f32 v148, v148, v208
  v_exp_f32 v210, v210
  v_add_f32 v149, v149, v209
  v_exp_f32 v211, v211
  v_add_f32 v148, v148, v210
  v_exp_f32 v212, v212
  v_add_f32 v149, v149, v211
  v_exp_f32 v213, v213
  v_add_f32 v150, v150, v212
  v_exp_f32 v214, v214
  v_add_f32 v151, v151, v213
  v_exp_f32 v215, v215
  v_add_f32 v150, v150, v214
  v_exp_f32 v216, v216
  v_add_f32 v151, v151, v215
  v_exp_f32 v217, v217
  v_add_f32 v150, v150, v216
  v_exp_f32 v218, v218
  v_add_f32 v151, v151, v217
  v_exp_f32 v219, v219
  v_add_f32 v150, v150, v218
  v_cvt_pk_bf16_f32 v228, v204, v205
  v_add_f32 v151, v151, v219
  v_cvt_pk_bf16_f32 v229, v206, v207
  v_add_f32 v148, v148, v149
  v_add_f32 v150, v150, v151
  v_mov_b32 v149, v148
  v_mov_b32 v151, v150
  v_cvt_pk_bf16_f32 v230, v208, v209
  v_permlane16_swap_b32 v148, v149
  v_permlane16_swap_b32 v150, v151
  v_cvt_pk_bf16_f32 v231, v210, v211
  v_add_f32 v148, v148, v149
  v_add_f32 v150, v150, v151
  v_mov_b32 v149, v148
  v_mov_b32 v151, v150
  v_cvt_pk_bf16_f32 v232, v212, v213
  v_permlane32_swap_b32 v148, v149
  v_permlane32_swap_b32 v150, v151
  v_cvt_pk_bf16_f32 v233, v214, v215
  v_add_f32 v148, v148, v149
  v_add_f32 v150, v150, v151
  v_max_f32 v28, v148, v150
  v_min_f32 v29, v148, v150
  v_add_f32 v33, v148, v150
  v_cmp_nle_f32 vcc, v28, s60
  v_cmp_nge_f32 s[64:65], v29, s61
  v_cmp_u_f32 s[66:67], v33, v33
  v_cvt_pk_bf16_f32 v234, v216, v217
  v_cvt_pk_bf16_f32 v235, v218, v219
  v_rcp_f32 v28, v148
  v_rcp_f32 v29, v150
  s_or_b64 vcc, vcc, s[64:65]
  s_or_b64 vcc, vcc, s[66:67]
  s_cbranch_scc1 L_slow
  s_waitcnt lgkmcnt(8)
  v_mfma_f32_16x16x32_bf16 v[68:71], v[36:39], v[140:143], v[68:71]
  ds_read_b64_tr_b16 v[60:61], v14 offset:40960
  v_mfma_f32_16x16x32_bf16 v[72:75], v[36:39], v[144:147], v[72:75]
  ds_read_b64_tr_b16 v[62:63], v14 offset:45056
  v_mfma_f32_16x16x32_bf16 v[76:79], v[40:43], v[140:143], v[76:79]
  ds_read_b64_tr_b16 v[64:65], v15 offset:40960
  v_mfma_f32_16x16x32_bf16 v[80:83], v[40:43], v[144:147], v[80:83]
  ds_read_b64_tr_b16 v[66:67], v15 offset:45056
  s_waitcnt lgkmcnt(8)
  v_mfma_f32_16x16x32_bf16 v[68:71], v[44:47], v[132:135], v[68:71]
  ds_read_b64_tr_b16 v[36:37], v14 offset:49152
  v_mfma_f32_16x16x32_bf16 v[72:75], v[44:47], v[136:139], v[72:75]
  ds_read_b64_tr_b16 v[38:39], v14 offset:53248
  v_mfma_f32_16x16x32_bf16 v[76:79], v[48:51], v[132:135], v[76:79]
  ds_read_b64_tr_b16 v[40:41], v15 offset:49152
  v_mfma_f32_16x16x32_bf16 v[80:83], v[48:51], v[136:139], v[80:83]
  ds_read_b64_tr_b16 v[42:43], v15 offset:53248
  s_waitcnt lgkmcnt(8)
  v_mfma_f32_16x16x32_bf16 v[68:71], v[52:55], v[228:231], v[68:71]
  ds_read_b64_tr_b16 v[44:45], v14 offset:57344
  v_mfma_f32_16x16x32_bf16 v[72:75], v[52:55], v[232:235], v[72:75]
  ds_read_b64_tr_b16 v[46:47], v14 offset:61440
  v_mfma_f32_16x16x32_bf16 v[76:79], v[56:59], v[228:231], v[76:79]
  ds_read_b64_tr_b16 v[48:49], v15 offset:57344
  v_mfma_f32_16x16x32_bf16 v[80:83], v[56:59], v[232:235], v[80:83]
  ds_read_b64_tr_b16 v[50:51], v15 offset:61440
  s_waitcnt lgkmcnt(8)
  v_mfma_f32_16x16x32_bf16 v[84:87], v[60:63], v[140:143], v[84:87]
  v_mul_f32 v68, v28, v68
  v_mul_f32 v69, v28, v69
  ds_read_b64_tr_b16 v[52:53], v16 offset:40960
  v_mfma_f32_16x16x32_bf16 v[88:91], v[60:63], v[144:147], v[88:91]
  v_mul_f32 v70, v28, v70
  v_mul_f32 v71, v28, v71
  ds_read_b64_tr_b16 v[54:55], v16 offset:45056
  v_mfma_f32_16x16x32_bf16 v[92:95], v[64:67], v[140:143], v[92:95]
  v_cvt_pk_bf16_f32 v156, v68, v69
  v_cvt_pk_bf16_f32 v157, v70, v71
  ds_read_b64_tr_b16 v[56:57], v17 offset:40960
  v_mfma_f32_16x16x32_bf16 v[96:99], v[64:67], v[144:147], v[96:99]
  v_mul_f32 v76, v28, v76
  v_mul_f32 v77, v28, v77
  ds_read_b64_tr_b16 v[58:59], v17 offset:45056
  s_waitcnt lgkmcnt(8)
  v_mfma_f32_16x16x32_bf16 v[84:87], v[36:39], v[132:135], v[84:87]
  v_mul_f32 v78, v28, v78
  v_mul_f32 v79, v28, v79
  ds_read_b64_tr_b16 v[60:61], v16 offset:49152
  v_mfma_f32_16x16x32_bf16 v[88:91], v[36:39], v[136:139], v[88:91]
  v_cvt_pk_bf16_f32 v158, v76, v77
  v_cvt_pk_bf16_f32 v159, v78, v79
  ds_read_b64_tr_b16 v[62:63], v16 offset:53248
  buffer_store_dwordx4 v[156:159], v27, s[28:31], s52 offen offset:0 sc1
  v_mfma_f32_16x16x32_bf16 v[92:95], v[40:43], v[132:135], v[92:95]
  v_mul_f32 v72, v29, v72
  v_mul_f32 v73, v29, v73
  ds_read_b64_tr_b16 v[64:65], v17 offset:49152
  v_mfma_f32_16x16x32_bf16 v[96:99], v[40:43], v[136:139], v[96:99]
  v_mul_f32 v74, v29, v74
  v_mul_f32 v75, v29, v75
  ds_read_b64_tr_b16 v[66:67], v17 offset:53248
  s_waitcnt lgkmcnt(8)
  v_mfma_f32_16x16x32_bf16 v[84:87], v[44:47], v[228:231], v[84:87]
  v_cvt_pk_bf16_f32 v172, v72, v73
  v_cvt_pk_bf16_f32 v173, v74, v75
  ds_read_b64_tr_b16 v[36:37], v16 offset:57344
  v_mfma_f32_16x16x32_bf16 v[88:91], v[44:47], v[232:235], v[88:91]
  v_mul_f32 v80, v29, v80
  v_mul_f32 v81, v29, v81
  ds_read_b64_tr_b16 v[38:39], v16 offset:61440
  v_mfma_f32_16x16x32_bf16 v[92:95], v[48:51], v[228:231], v[92:95]
  v_mul_f32 v82, v29, v82
  v_mul_f32 v83, v29, v83
  ds_read_b64_tr_b16 v[40:41], v17 offset:57344
  v_mfma_f32_16x16x32_bf16 v[96:99], v[48:51], v[232:235], v[96:99]
  v_cvt_pk_bf16_f32 v174, v80, v81
  v_cvt_pk_bf16_f32 v175, v82, v83
  ds_read_b64_tr_b16 v[42:43], v17 offset:61440
  buffer_store_dwordx4 v[172:175], v27, s[28:31], s53 offen offset:0 sc1
  s_waitcnt lgkmcnt(8)
  v_mfma_f32_16x16x32_bf16 v[100:103], v[52:55], v[140:143], v[100:103]
  v_mul_f32 v84, v28, v84
  v_mul_f32 v85, v28, v85
  ds_read_b64_tr_b16 v[44:45], v18 offset:40960
  v_mfma_f32_16x16x32_bf16 v[104:107], v[52:55], v[144:147], v[104:107]
  v_mul_f32 v86, v28, v86
  v_mul_f32 v87, v28, v87
  ds_read_b64_tr_b16 v[46:47], v18 offset:45056
  v_mfma_f32_16x16x32_bf16 v[108:111], v[56:59], v[140:143], v[108:111]
  v_cvt_pk_bf16_f32 v160, v84, v85
  v_cvt_pk_bf16_f32 v161, v86, v87
  ds_read_b64_tr_b16 v[48:49], v19 offset:40960
  v_mfma_f32_16x16x32_bf16 v[112:115], v[56:59], v[144:147], v[112:115]
  v_mul_f32 v92, v28, v92
  v_mul_f32 v93, v28, v93
  ds_read_b64_tr_b16 v[50:51], v19 offset:45056
  s_waitcnt lgkmcnt(8)
  v_mfma_f32_16x16x32_bf16 v[100:103], v[60:63], v[132:135], v[100:103]
  v_mul_f32 v94, v28, v94
  v_mul_f32 v95, v28, v95
  ds_read_b64_tr_b16 v[52:53], v18 offset:49152
  v_mfma_f32_16x16x32_bf16 v[104:107], v[60:63], v[136:139], v[104:107]
  v_cvt_pk_bf16_f32 v162, v92, v93
  v_cvt_pk_bf16_f32 v163, v94, v95
  ds_read_b64_tr_b16 v[54:55], v18 offset:53248
  buffer_store_dwordx4 v[160:163], v27, s[28:31], s52 offen offset:1024 sc1
  v_mfma_f32_16x16x32_bf16 v[108:111], v[64:67], v[132:135], v[108:111]
  v_mul_f32 v88, v29, v88
  v_mul_f32 v89, v29, v89
  ds_read_b64_tr_b16 v[56:57], v19 offset:49152
  v_mfma_f32_16x16x32_bf16 v[112:115], v[64:67], v[136:139], v[112:115]
  v_mul_f32 v90, v29, v90
  v_mul_f32 v91, v29, v91
  ds_read_b64_tr_b16 v[58:59], v19 offset:53248
  s_waitcnt lgkmcnt(8)
  v_mfma_f32_16x16x32_bf16 v[100:103], v[36:39], v[228:231], v[100:103]
  v_cvt_pk_bf16_f32 v176, v88, v89
  v_cvt_pk_bf16_f32 v177, v90, v91
  ds_read_b64_tr_b16 v[60:61], v18 offset:57344
  v_mfma_f32_16x16x32_bf16 v[104:107], v[36:39], v[232:235], v[104:107]
  v_mul_f32 v96, v29, v96
  v_mul_f32 v97, v29, v97
  ds_read_b64_tr_b16 v[62:63], v18 offset:61440
  v_mfma_f32_16x16x32_bf16 v[108:111], v[40:43], v[228:231], v[108:111]
  v_mul_f32 v98, v29, v98
  v_mul_f32 v99, v29, v99
  ds_read_b64_tr_b16 v[64:65], v19 offset:57344
  v_mfma_f32_16x16x32_bf16 v[112:115], v[40:43], v[232:235], v[112:115]
  v_cvt_pk_bf16_f32 v178, v96, v97
  v_cvt_pk_bf16_f32 v179, v98, v99
  ds_read_b64_tr_b16 v[66:67], v19 offset:61440
  buffer_store_dwordx4 v[176:179], v27, s[28:31], s53 offen offset:1024 sc1
  s_waitcnt lgkmcnt(8)
  v_mfma_f32_16x16x32_bf16 v[116:119], v[44:47], v[140:143], v[116:119]
  v_mul_f32 v100, v28, v100
  v_mul_f32 v101, v28, v101
  v_mfma_f32_16x16x32_bf16 v[120:123], v[44:47], v[144:147], v[120:123]
  v_mul_f32 v102, v28, v102
  v_mul_f32 v103, v28, v103
  v_mfma_f32_16x16x32_bf16 v[124:127], v[48:51], v[140:143], v[124:127]
  v_cvt_pk_bf16_f32 v164, v100, v101
  v_cvt_pk_bf16_f32 v165, v102, v103
  v_mfma_f32_16x16x32_bf16 v[128:131], v[48:51], v[144:147], v[128:131]
  v_mul_f32 v108, v28, v108
  v_mul_f32 v109, v28, v109
  s_waitcnt lgkmcnt(4)
  v_mfma_f32_16x16x32_bf16 v[116:119], v[52:55], v[132:135], v[116:119]
  v_mul_f32 v110, v28, v110
  v_mul_f32 v111, v28, v111
  v_mfma_f32_16x16x32_bf16 v[120:123], v[52:55], v[136:139], v[120:123]
  v_cvt_pk_bf16_f32 v166, v108, v109
  v_cvt_pk_bf16_f32 v167, v110, v111
  buffer_store_dwordx4 v[164:167], v27, s[28:31], s52 offen offset:2048 sc1
  v_mfma_f32_16x16x32_bf16 v[124:127], v[56:59], v[132:135], v[124:127]
  v_mul_f32 v104, v29, v104
  v_mul_f32 v105, v29, v105
  v_mfma_f32_16x16x32_bf16 v[128:131], v[56:59], v[136:139], v[128:131]
  v_mul_f32 v106, v29, v106
  v_mul_f32 v107, v29, v107
  s_waitcnt lgkmcnt(0)
  v_mfma_f32_16x16x32_bf16 v[116:119], v[60:63], v[228:231], v[116:119]
  v_cvt_pk_bf16_f32 v180, v104, v105
  v_cvt_pk_bf16_f32 v181, v106, v107
  v_mfma_f32_16x16x32_bf16 v[120:123], v[60:63], v[232:235], v[120:123]
  v_mul_f32 v112, v29, v112
  v_mul_f32 v113, v29, v113
  v_mfma_f32_16x16x32_bf16 v[124:127], v[64:67], v[228:231], v[124:127]
  v_mul_f32 v114, v29, v114
  v_mul_f32 v115, v29, v115
  v_mfma_f32_16x16x32_bf16 v[128:131], v[64:67], v[232:235], v[128:131]
  v_cvt_pk_bf16_f32 v182, v112, v113
  v_cvt_pk_bf16_f32 v183, v114, v115
  buffer_store_dwordx4 v[180:183], v27, s[28:31], s53 offen offset:2048 sc1
  v_mul_f32 v116, v28, v116
  v_mul_f32 v117, v28, v117
  v_mul_f32 v118, v28, v118
  v_mul_f32 v119, v28, v119
  v_cvt_pk_bf16_f32 v168, v116, v117
  v_cvt_pk_bf16_f32 v169, v118, v119
  v_mul_f32 v124, v28, v124
  v_mul_f32 v125, v28, v125
  v_mul_f32 v126, v28, v126
  v_mul_f32 v127, v28, v127
  v_cvt_pk_bf16_f32 v170, v124, v125
  v_cvt_pk_bf16_f32 v171, v126, v127
  buffer_store_dwordx4 v[168:171], v27, s[28:31], s52 offen offset:3072 sc1
  v_mul_f32 v120, v29, v120
  v_mul_f32 v121, v29, v121
  v_mul_f32 v122, v29, v122
  v_mul_f32 v123, v29, v123
  v_cvt_pk_bf16_f32 v184, v120, v121
  v_cvt_pk_bf16_f32 v185, v122, v123
  v_mul_f32 v128, v29, v128
  v_mul_f32 v129, v29, v129
  v_mul_f32 v130, v29, v130
  v_mul_f32 v131, v29, v131
  v_cvt_pk_bf16_f32 v186, v128, v129
  v_cvt_pk_bf16_f32 v187, v130, v131
  buffer_store_dwordx4 v[184:187], v27, s[28:31], s53 offen offset:3072 sc1
L_join:
  s_load_dwordx2 s[32:33], s[0:1], 80
  s_lshr_b32 s87, s36, 2
  s_and_b32 s88, s36, 3
  s_lshl_b32 s60, s84, 3
  s_lshl_b32 s61, s88, 1
  s_add_u32 s60, s60, s61
  s_lshl_b32 s90, s60, 7
  s_mul_i32 s61, s85, 43
  s_add_u32 s90, s90, s61
  s_add_u32 s90, s90, s87
  s_lshl_b32 s90, s90, 10
  s_add_u32 s90, s90, 4194304
  s_mul_i32 s61, s60, 43
  s_add_u32 s61, s61, s87
  s_lshl_b32 s61, s61, 10
  s_add_u32 s61, s61, 25165824
  s_mov_b32 s91, 131072
  s_cmp_eq_u32 s85, 3
  s_cselect_b32 s90, s61, s90
  s_cselect_b32 s91, 44032, s91
  s_add_u32 s91, s91, s90
  s_lshl_b32 s92, s87, 10
  s_sub_u32 s92, 43008, s92
  s_cmp_eq_u32 s85, 2
  s_cselect_b32 s92, 0, s92
  s_lshl_b32 s82, s87, 11
  s_sub_u32 s82, 1024, s82
  s_lshl_b32 s70, s83, 2
  s_add_u32 s70, s70, s85
  s_lshl_b32 s70, s70, 13
  s_add_u32 s70, s70, s45
  s_add_u32 s70, s70, 33554432
  s_lshl_b32 s68, s84, 7
  s_lshl_b32 s61, s88, 5
  s_add_u32 s68, s68, s61
  s_and_b32 s61, s85, 1
  s_lshl_b32 s61, s61, 4
  s_add_u32 s68, s68, s61
  s_lshl_b32 s69, s86, 7
  s_lshl_b32 s61, s87, 6
  s_add_u32 s69, s69, s61
  s_lshr_b32 s61, s85, 1
  s_lshl_b32 s61, s61, 5
  s_add_u32 s69, s69, s61
  s_lshl_b32 s69, s69, 1
  s_lshl_b32 s68, s68, 10
  s_add_u32 s68, s68, s69
  s_mov_b32 s16, s94
  s_mov_b32 s17, s95
  s_mov_b32 s18, 1024
  s_mov_b32 s19, 0x20000
  s_mov_b32 s73, 0xfffffffe
  s_mov_b32 s72, 0
  s_add_u32 s74, s70, 0
  s_cmp_eq_u32 s85, 0
  s_cselect_b32 s74, 0x40000000, s74
  s_add_u32 s75, s70, 32768
  s_cmp_eq_u32 s85, 1
  s_cselect_b32 s75, 0x40000000, s75
  s_add_u32 s76, s70, 65536
  s_cmp_eq_u32 s85, 2
  s_cselect_b32 s76, 0x40000000, s76
  s_add_u32 s77, s70, 98304
  s_cmp_eq_u32 s85, 3
  s_cselect_b32 s77, 0x40000000, s77
  v_bfe_u32 v33, v1, 2, 2
  v_lshl_add_u32 v29, v24, 2, v33
  v_and_b32 v28, 7, v29
  s_lshl_b32 s60, s87, 2
  v_xor_b32 v28, s60, v28
  v_and_b32 v34, 3, v1
  v_lshlrev_b32 v34, 3, v34
  v_lshl_add_u32 v28, v28, 5, v34
  v_lshl_add_u32 v28, v29, 8, v28
  s_lshl_b32 s60, s87, 13
  v_add_u32 v4, s60, v28
  v_xor_b32 v5, 32, v4
  v_xor_b32 v6, 64, v4
  v_xor_b32 v7, 96, v4
  v_xor_b32 v8, 128, v4
  v_xor_b32 v9, 160, v4
  v_xor_b32 v10, 192, v4
  v_xor_b32 v11, 224, v4
  v_add_u32 v12, 0x10000, v4
  v_add_u32 v13, 0x10000, v5
  v_add_u32 v14, 0x10000, v6
  v_add_u32 v15, 0x10000, v7
  v_add_u32 v16, 0x10000, v8
  v_add_u32 v17, 0x10000, v9
  v_add_u32 v18, 0x10000, v10
  v_add_u32 v19, 0x10000, v11
  v_xor_b32 v220, 0x2000, v4
  v_xor_b32 v221, 0x2000, v5
  v_xor_b32 v222, 0x2000, v6
  v_xor_b32 v223, 0x2000, v7
  v_xor_b32 v224, 0x2000, v12
  v_xor_b32 v225, 0x2000, v13
  v_xor_b32 v226, 0x2000, v14
  v_xor_b32 v227, 0x2000, v15
  v_lshlrev_b32 v28, 4, v24
  v_lshl_add_u32 v3, v25, 10, v28
  v_lshlrev_b32 v35, 3, v24
  s_lshl_b32 s60, s36, 13
  s_xor_b32 s60, s60, 0
  s_add_u32 s60, s60, 0x18000
  s_and_b32 s60, s60, 0x1ffff
  v_add_u32 v20, s60, v27
  s_lshl_b32 s60, s36, 13
  s_xor_b32 s60, s60, 32768
  s_add_u32 s60, s60, 0x18000
  s_and_b32 s60, s60, 0x1ffff
  v_add_u32 v21, s60, v27
  s_lshl_b32 s61, s38, 5
  s_add_u32 s60, s61, s37
  s_lshl_b32 s60, s60, 6
  s_add_u32 s60, s60, 48234496
  v_subrev_u32 v30, 31, v1
  v_min_u32 v30, 3, v30
  v_lshlrev_b32 v30, 3, v30
  v_xor_b32 v30, s37, v30
  v_add_u32 v30, s61, v30
  s_lshr_b32 s61, s84, 1
  s_lshl_b32 s61, s61, 5
  v_add_u32 v31, s61, v1
  v_cmp_gt_u32 vcc, 32, v1
  s_nop 1
  v_cndmask_b32 v30, v30, v31, vcc
  v_lshlrev_b32 v30, 6, v30
  v_mov_b32 v31, s97
  v_mov_b32 v32, 0
  s_mov_b32 s61, 48234496
  s_mov_b64 s[64:65], -1
  s_waitcnt vmcnt(0) lgkmcnt(0)
  s_mov_b32 s20, s32
  s_mov_b32 s21, s33
  s_mov_b32 s22, 2097152
  s_mov_b32 s23, 0x20000
  s_barrier
  s_cmp_eq_u32 s36, 0
  s_cselect_b64 exec, 1, 0
  buffer_store_dword v31, v32, s[28:31], s60 offen sc1
  s_mov_b64 exec, -1
  s_add_u32 s62, s89, 196608
  s_add_u32 m0, s45, 32768
  s_nop 0
  buffer_load_dwordx4 v2, s[12:15], s62 offen lds
  s_add_u32 s63, s89, 229376
  s_add_u32 m0, s45, 40960
  s_nop 0
  buffer_load_dwordx4 v2, s[12:15], s63 offen lds
  s_add_u32 s62, s89, 262144
  s_add_u32 m0, s45, 81920
  s_nop 0
  buffer_load_dwordx4 v2, s[12:15], s62 offen lds
  s_add_u32 s63, s89, 294912
  s_add_u32 m0, s45, 90112
  s_nop 0
  buffer_load_dwordx4 v2, s[12:15], s63 offen lds
  s_add_u32 s62, s89, 327680
  s_add_u32 m0, s45, 49152
  s_nop 0
  buffer_load_dwordx4 v2, s[12:15], s62 offen lds
  s_add_u32 s63, s89, 360448
  s_add_u32 m0, s45, 57344
  s_nop 0
  buffer_load_dwordx4 v2, s[12:15], s63 offen lds
  s_add_u32 s62, s89, 393216
  s_add_u32 m0, s45, 98304
  s_nop 0
  buffer_load_dwordx4 v2, s[12:15], s62 offen lds
  s_add_u32 s63, s89, 425984
  s_add_u32 m0, s45, 106496
  s_nop 0
  buffer_load_dwordx4 v2, s[12:15], s63 offen lds
  s_add_u32 s62, s89, 458752
  s_add_u32 m0, s45, 114688
  s_nop 0
  buffer_load_dwordx4 v2, s[12:15], s62 offen lds
  s_add_u32 s63, s89, 491520
  s_add_u32 m0, s45, 122880
  s_nop 0
  buffer_load_dwordx4 v2, s[12:15], s63 offen lds
  s_cmp_lg_u32 s36, 0
  s_cbranch_scc1 L_fgo
L_fpoll:
  s_sleep 2
  buffer_load_dword v33, v30, s[28:31], s61 offen sc1
  s_add_u32 s72, s72, 1
  s_waitcnt vmcnt(0)
  v_cmp_ne_u32 vcc, s97, v33
  s_bitcmp1_b32 s72, 14
  s_cbranch_scc1 L_fgo
  s_nop 1
  s_and_b64 vcc, vcc, s[64:65]
  s_cbranch_scc1 L_fpoll
L_fgo:
  s_barrier
  s_mov_b32 s72, 0
  s_add_u32 s62, s90, 0
  buffer_load_dwordx4 v[132:135], v27, s[28:31], s62 offen sc1
  s_add_u32 s63, s91, 0
  buffer_load_dwordx4 v[136:139], v27, s[28:31], s63 offen sc1
  s_add_u32 s62, s90, 2048
  buffer_load_dwordx4 v[140:143], v27, s[28:31], s62 offen sc1
  s_add_u32 s63, s91, 2048
  buffer_load_dwordx4 v[144:147], v27, s[28:31], s63 offen sc1
  s_add_u32 s62, s90, 4096
  buffer_load_dwordx4 v[148:151], v27, s[28:31], s62 offen sc1
  s_add_u32 s63, s91, 4096
  buffer_load_dwordx4 v[152:155], v27, s[28:31], s63 offen sc1
  ds_read_b64_tr_b16 v[36:37], v4 offset:0
  ds_read_b64_tr_b16 v[38:39], v4 offset:4096
  ds_read_b64_tr_b16 v[40:41], v5 offset:0
  ds_read_b64_tr_b16 v[42:43], v5 offset:4096
  ds_read_b64_tr_b16 v[44:45], v6 offset:0
  ds_read_b64_tr_b16 v[46:47], v6 offset:4096
  ds_read_b64_tr_b16 v[48:49], v7 offset:0
  ds_read_b64_tr_b16 v[50:51], v7 offset:4096
  ds_read_b64_tr_b16 v[52:53], v8 offset:0
  ds_read_b64_tr_b16 v[54:55], v8 offset:4096
  s_waitcnt vmcnt(4) lgkmcnt(6)
  v_mfma_f32_16x16x32_bf16 v[68:71], v[36:39], v[132:135], 0
  ds_read_b64_tr_b16 v[56:57], v9 offset:0
  v_mfma_f32_16x16x32_bf16 v[72:75], v[36:39], v[136:139], 0
  s_add_u32 s62, s90, 6144
  ds_read_b64_tr_b16 v[58:59], v9 offset:4096
  buffer_load_dwordx4 v[156:159], v27, s[28:31], s62 offen sc1
  v_mfma_f32_16x16x32_bf16 v[76:79], v[40:43], v[132:135], 0
  ds_read_b64_tr_b16 v[60:61], v10 offset:0
  v_mfma_f32_16x16x32_bf16 v[80:83], v[40:43], v[136:139], 0
  ds_read_b64_tr_b16 v[62:63], v10 offset:4096
  s_waitcnt lgkmcnt(6)
  v_mfma_f32_16x16x32_bf16 v[84:87], v[44:47], v[132:135], 0
  ds_read_b64_tr_b16 v[64:65], v11 offset:0
  v_mfma_f32_16x16x32_bf16 v[88:91], v[44:47], v[136:139], 0
  s_add_u32 s63, s91, 6144
  ds_read_b64_tr_b16 v[66:67], v11 offset:4096
  buffer_load_dwordx4 v[160:163], v27, s[28:31], s63 offen sc1
  v_mfma_f32_16x16x32_bf16 v[92:95], v[48:51], v[132:135], 0
  ds_read_b64_tr_b16 v[36:37], v4 offset:16384
  v_mfma_f32_16x16x32_bf16 v[96:99], v[48:51], v[136:139], 0
  ds_read_b64_tr_b16 v[38:39], v4 offset:20480
  s_waitcnt lgkmcnt(6)
  v_mfma_f32_16x16x32_bf16 v[100:103], v[52:55], v[132:135], 0
  ds_read_b64_tr_b16 v[40:41], v5 offset:16384
  v_mfma_f32_16x16x32_bf16 v[104:107], v[52:55], v[136:139], 0
  s_add_u32 s62, s90, 8192
  ds_read_b64_tr_b16 v[42:43], v5 offset:20480
  buffer_load_dwordx4 v[164:167], v27, s[28:31], s62 offen sc1
  v_mfma_f32_16x16x32_bf16 v[108:111], v[56:59], v[132:135], 0
  ds_read_b64_tr_b16 v[44:45], v6 offset:16384
  v_mfma_f32_16x16x32_bf16 v[112:115], v[56:59], v[136:139], 0
  ds_read_b64_tr_b16 v[46:47], v6 offset:20480
  s_waitcnt lgkmcnt(6)
  v_mfma_f32_16x16x32_bf16 v[116:119], v[60:63], v[132:135], 0
  ds_read_b64_tr_b16 v[48:49], v7 offset:16384
  v_mfma_f32_16x16x32_bf16 v[120:123], v[60:63], v[136:139], 0
  ds_read_b64_tr_b16 v[50:51], v7 offset:20480
  v_mfma_f32_16x16x32_bf16 v[124:127], v[64:67], v[132:135], 0
  s_add_u32 s63, s91, 8192
  ds_read_b64_tr_b16 v[52:53], v8 offset:16384
  buffer_load_dwordx4 v[168:171], v27, s[28:31], s63 offen sc1
  v_mfma_f32_16x16x32_bf16 v[128:131], v[64:67], v[136:139], 0
  ds_read_b64_tr_b16 v[54:55], v8 offset:20480
  s_waitcnt vmcnt(6) lgkmcnt(6)
  v_mfma_f32_16x16x32_bf16 v[68:71], v[36:39], v[140:143], v[68:71]
  ds_read_b64_tr_b16 v[56:57], v9 offset:16384
  v_mfma_f32_16x16x32_bf16 v[72:75], v[36:39], v[144:147], v[72:75]
  ds_read_b64_tr_b16 v[58:59], v9 offset:20480
  v_mfma_f32_16x16x32_bf16 v[76:79], v[40:43], v[140:143], v[76:79]
  s_add_u32 s62, s90, 10240
  ds_read_b64_tr_b16 v[60:61], v10 offset:16384
  buffer_load_dwordx4 v[172:175], v27, s[28:31], s62 offen sc1
  v_mfma_f32_16x16x32_bf16 v[80:83], v[40:43], v[144:147], v[80:83]
  ds_read_b64_tr_b16 v[62:63], v10 offset:20480
  s_waitcnt lgkmcnt(6)
  v_mfma_f32_16x16x32_bf16 v[84:87], v[44:47], v[140:143], v[84:87]
  ds_read_b64_tr_b16 v[64:65], v11 offset:16384
  v_mfma_f32_16x16x32_bf16 v[88:91], v[44:47], v[144:147], v[88:91]
  ds_read_b64_tr_b16 v[66:67], v11 offset:20480
  v_mfma_f32_16x16x32_bf16 v[92:95], v[48:51], v[140:143], v[92:95]
  s_barrier
  ds_read_b64_tr_b16 v[36:37], v12 offset:0
  v_mfma_f32_16x16x32_bf16 v[96:99], v[48:51], v[144:147], v[96:99]
  s_add_u32 s63, s91, 10240
  ds_read_b64_tr_b16 v[38:39], v12 offset:4096
  buffer_load_dwordx4 v[176:179], v27, s[28:31], s63 offen sc1
  s_waitcnt lgkmcnt(6)
  v_mfma_f32_16x16x32_bf16 v[100:103], v[52:55], v[140:143], v[100:103]
  ds_read_b64_tr_b16 v[40:41], v13 offset:0
  v_mfma_f32_16x16x32_bf16 v[104:107], v[52:55], v[144:147], v[104:107]
  ds_read_b64_tr_b16 v[42:43], v13 offset:4096
  v_mfma_f32_16x16x32_bf16 v[108:111], v[56:59], v[140:143], v[108:111]
  ds_read_b64_tr_b16 v[44:45], v14 offset:0
  v_mfma_f32_16x16x32_bf16 v[112:115], v[56:59], v[144:147], v[112:115]
  s_add_u32 s62, s90, 12288
  ds_read_b64_tr_b16 v[46:47], v14 offset:4096
  buffer_load_dwordx4 v[180:183], v27, s[28:31], s62 offen sc1
  s_waitcnt lgkmcnt(6)
  v_mfma_f32_16x16x32_bf16 v[116:119], v[60:63], v[140:143], v[116:119]
  ds_read_b64_tr_b16 v[48:49], v15 offset:0
  v_mfma_f32_16x16x32_bf16 v[120:123], v[60:63], v[144:147], v[120:123]
  ds_read_b64_tr_b16 v[50:51], v15 offset:4096
  v_mfma_f32_16x16x32_bf16 v[124:127], v[64:67], v[140:143], v[124:127]
  ds_read_b64_tr_b16 v[52:53], v16 offset:0
  v_mfma_f32_16x16x32_bf16 v[128:131], v[64:67], v[144:147], v[128:131]
  s_add_u32 s63, s91, 12288
  ds_read_b64_tr_b16 v[54:55], v16 offset:4096
  buffer_load_dwordx4 v[184:187], v27, s[28:31], s63 offen sc1
  s_waitcnt vmcnt(8) lgkmcnt(6)
  v_mfma_f32_16x16x32_bf16 v[68:71], v[36:39], v[148:151], v[68:71]
  ds_read_b64_tr_b16 v[56:57], v17 offset:0
  v_mfma_f32_16x16x32_bf16 v[72:75], v[36:39], v[152:155], v[72:75]
  ds_read_b64_tr_b16 v[58:59], v17 offset:4096
  v_mfma_f32_16x16x32_bf16 v[76:79], v[40:43], v[148:151], v[76:79]
  ds_read_b64_tr_b16 v[60:61], v18 offset:0
  v_mfma_f32_16x16x32_bf16 v[80:83], v[40:43], v[152:155], v[80:83]
  ds_read_b64_tr_b16 v[62:63], v18 offset:4096
  s_waitcnt lgkmcnt(6)
  v_mfma_f32_16x16x32_bf16 v[84:87], v[44:47], v[148:151], v[84:87]
  s_add_u32 s62, s90, 14336
  ds_read_b64_tr_b16 v[64:65], v19 offset:0
  buffer_load_dwordx4 v[188:191], v27, s[28:31], s62 offen sc1
  v_mfma_f32_16x16x32_bf16 v[88:91], v[44:47], v[152:155], v[88:91]
  ds_read_b64_tr_b16 v[66:67], v19 offset:4096
  v_mfma_f32_16x16x32_bf16 v[92:95], v[48:51], v[148:151], v[92:95]
  s_barrier
  ds_read_b64_tr_b16 v[36:37], v4 offset:32768
  v_mfma_f32_16x16x32_bf16 v[96:99], v[48:51], v[152:155], v[96:99]
  ds_read_b64_tr_b16 v[38:39], v4 offset:36864
  s_waitcnt lgkmcnt(6)
  v_mfma_f32_16x16x32_bf16 v[100:103], v[52:55], v[148:151], v[100:103]
  s_add_u32 s63, s91, 14336
  ds_read_b64_tr_b16 v[40:41], v5 offset:32768
  buffer_load_dwordx4 v[192:195], v27, s[28:31], s63 offen sc1
  v_mfma_f32_16x16x32_bf16 v[104:107], v[52:55], v[152:155], v[104:107]
  ds_read_b64_tr_b16 v[42:43], v5 offset:36864
  v_mfma_f32_16x16x32_bf16 v[108:111], v[56:59], v[148:151], v[108:111]
  ds_read_b64_tr_b16 v[44:45], v6 offset:32768
  v_mfma_f32_16x16x32_bf16 v[112:115], v[56:59], v[152:155], v[112:115]
  ds_read_b64_tr_b16 v[46:47], v6 offset:36864
  s_waitcnt lgkmcnt(6)
  v_mfma_f32_16x16x32_bf16 v[116:119], v[60:63], v[148:151], v[116:119]
  s_add_u32 s62, s89, 524288
  s_add_u32 m0, s45, 0
  ds_read_b64_tr_b16 v[48:49], v7 offset:32768
  buffer_load_dwordx4 v2, s[12:15], s62 offen lds
  v_mfma_f32_16x16x32_bf16 v[120:123], v[60:63], v[152:155], v[120:123]
  ds_read_b64_tr_b16 v[50:51], v7 offset:36864
  v_mfma_f32_16x16x32_bf16 v[124:127], v[64:67], v[148:151], v[124:127]
  ds_read_b64_tr_b16 v[52:53], v8 offset:32768
  v_mfma_f32_16x16x32_bf16 v[128:131], v[64:67], v[152:155], v[128:131]
  ds_read_b64_tr_b16 v[54:55], v8 offset:36864
  s_waitcnt vmcnt(9) lgkmcnt(6)
  v_mfma_f32_16x16x32_bf16 v[68:71], v[36:39], v[156:159], v[68:71]
  ds_read_b64_tr_b16 v[56:57], v9 offset:32768
  v_mfma_f32_16x16x32_bf16 v[72:75], v[36:39], v[160:163], v[72:75]
  s_add_u32 s63, s89, 557056
  s_add_u32 m0, s45, 8192
  ds_read_b64_tr_b16 v[58:59], v9 offset:36864
  buffer_load_dwordx4 v2, s[12:15], s63 offen lds
  v_mfma_f32_16x16x32_bf16 v[76:79], v[40:43], v[156:159], v[76:79]
  ds_read_b64_tr_b16 v[60:61], v10 offset:32768
  v_mfma_f32_16x16x32_bf16 v[80:83], v[40:43], v[160:163], v[80:83]
  ds_read_b64_tr_b16 v[62:63], v10 offset:36864
  s_waitcnt lgkmcnt(6)
  v_mfma_f32_16x16x32_bf16 v[84:87], v[44:47], v[156:159], v[84:87]
  ds_read_b64_tr_b16 v[64:65], v11 offset:32768
  v_mfma_f32_16x16x32_bf16 v[88:91], v[44:47], v[160:163], v[88:91]
  s_add_u32 s62, s90, 16384
  ds_read_b64_tr_b16 v[66:67], v11 offset:36864
  buffer_load_dwordx4 v[132:135], v27, s[28:31], s62 offen sc1
  v_mfma_f32_16x16x32_bf16 v[92:95], v[48:51], v[156:159], v[92:95]
  s_barrier
  ds_read_b64_tr_b16 v[36:37], v12 offset:16384
  v_mfma_f32_16x16x32_bf16 v[96:99], v[48:51], v[160:163], v[96:99]
  ds_read_b64_tr_b16 v[38:39], v12 offset:20480
  s_waitcnt lgkmcnt(6)
  v_mfma_f32_16x16x32_bf16 v[100:103], v[52:55], v[156:159], v[100:103]
  ds_read_b64_tr_b16 v[40:41], v13 offset:16384
  v_mfma_f32_16x16x32_bf16 v[104:107], v[52:55], v[160:163], v[104:107]
  ds_read_b64_tr_b16 v[42:43], v13 offset:20480
  v_mfma_f32_16x16x32_bf16 v[108:111], v[56:59], v[156:159], v[108:111]
  s_add_u32 s63, s91, 16384
  ds_read_b64_tr_b16 v[44:45], v14 offset:16384
  buffer_load_dwordx4 v[136:139], v27, s[28:31], s63 offen sc1
  v_mfma_f32_16x16x32_bf16 v[112:115], v[56:59], v[160:163], v[112:115]
  ds_read_b64_tr_b16 v[46:47], v14 offset:20480
  s_waitcnt lgkmcnt(6)
  v_mfma_f32_16x16x32_bf16 v[116:119], v[60:63], v[156:159], v[116:119]
  ds_read_b64_tr_b16 v[48:49], v15 offset:16384
  v_mfma_f32_16x16x32_bf16 v[120:123], v[60:63], v[160:163], v[120:123]
  ds_read_b64_tr_b16 v[50:51], v15 offset:20480
  v_mfma_f32_16x16x32_bf16 v[124:127], v[64:67], v[156:159], v[124:127]
  s_add_u32 s62, s89, 589824
  s_add_u32 m0, s45, 16384
  ds_read_b64_tr_b16 v[52:53], v16 offset:16384
  buffer_load_dwordx4 v2, s[12:15], s62 offen lds
  v_mfma_f32_16x16x32_bf16 v[128:131], v[64:67], v[160:163], v[128:131]
  ds_read_b64_tr_b16 v[54:55], v16 offset:20480
  s_waitcnt vmcnt(11) lgkmcnt(6)
  v_mfma_f32_16x16x32_bf16 v[68:71], v[36:39], v[164:167], v[68:71]
  ds_read_b64_tr_b16 v[56:57], v17 offset:16384
  v_mfma_f32_16x16x32_bf16 v[72:75], v[36:39], v[168:171], v[72:75]
  ds_read_b64_tr_b16 v[58:59], v17 offset:20480
  v_mfma_f32_16x16x32_bf16 v[76:79], v[40:43], v[164:167], v[76:79]
  s_add_u32 s63, s89, 622592
  s_add_u32 m0, s45, 24576
  ds_read_b64_tr_b16 v[60:61], v18 offset:16384
  buffer_load_dwordx4 v2, s[12:15], s63 offen lds
  v_mfma_f32_16x16x32_bf16 v[80:83], v[40:43], v[168:171], v[80:83]
  ds_read_b64_tr_b16 v[62:63], v18 offset:20480
  s_waitcnt lgkmcnt(6)
  v_mfma_f32_16x16x32_bf16 v[84:87], v[44:47], v[164:167], v[84:87]
  ds_read_b64_tr_b16 v[64:65], v19 offset:16384
  v_mfma_f32_16x16x32_bf16 v[88:91], v[44:47], v[168:171], v[88:91]
  ds_read_b64_tr_b16 v[66:67], v19 offset:20480
  v_mfma_f32_16x16x32_bf16 v[92:95], v[48:51], v[164:167], v[92:95]
  s_barrier
  ds_read_b64_tr_b16 v[36:37], v4 offset:49152
  v_mfma_f32_16x16x32_bf16 v[96:99], v[48:51], v[168:171], v[96:99]
  s_add_u32 s62, s90, 18432
  ds_read_b64_tr_b16 v[38:39], v4 offset:53248
  buffer_load_dwordx4 v[140:143], v27, s[28:31], s62 offen sc1
  s_waitcnt lgkmcnt(6)
  v_mfma_f32_16x16x32_bf16 v[100:103], v[52:55], v[164:167], v[100:103]
  ds_read_b64_tr_b16 v[40:41], v5 offset:49152
  v_mfma_f32_16x16x32_bf16 v[104:107], v[52:55], v[168:171], v[104:107]
  ds_read_b64_tr_b16 v[42:43], v5 offset:53248
  v_mfma_f32_16x16x32_bf16 v[108:111], v[56:59], v[164:167], v[108:111]
  ds_read_b64_tr_b16 v[44:45], v6 offset:49152
  v_mfma_f32_16x16x32_bf16 v[112:115], v[56:59], v[168:171], v[112:115]
  s_add_u32 s63, s91, 18432
  ds_read_b64_tr_b16 v[46:47], v6 offset:53248
  buffer_load_dwordx4 v[144:147], v27, s[28:31], s63 offen sc1
  s_waitcnt lgkmcnt(6)
  v_mfma_f32_16x16x32_bf16 v[116:119], v[60:63], v[164:167], v[116:119]
  ds_read_b64_tr_b16 v[48:49], v7 offset:49152
  v_mfma_f32_16x16x32_bf16 v[120:123], v[60:63], v[168:171], v[120:123]
  ds_read_b64_tr_b16 v[50:51], v7 offset:53248
  v_mfma_f32_16x16x32_bf16 v[124:127], v[64:67], v[164:167], v[124:127]
  ds_read_b64_tr_b16 v[52:53], v8 offset:49152
  v_mfma_f32_16x16x32_bf16 v[128:131], v[64:67], v[168:171], v[128:131]
  ds_read_b64_tr_b16 v[54:55], v8 offset:53248
  s_waitcnt vmcnt(12) lgkmcnt(6)
  v_mfma_f32_16x16x32_bf16 v[68:71], v[36:39], v[172:175], v[68:71]
  s_add_u32 s62, s89, 655360
  s_add_u32 m0, s45, 65536
  ds_read_b64_tr_b16 v[56:57], v9 offset:49152
  buffer_load_dwordx4 v2, s[12:15], s62 offen lds
  v_mfma_f32_16x16x32_bf16 v[72:75], v[36:39], v[176:179], v[72:75]
  ds_read_b64_tr_b16 v[58:59], v9 offset:53248
  v_mfma_f32_16x16x32_bf16 v[76:79], v[40:43], v[172:175], v[76:79]
  ds_read_b64_tr_b16 v[60:61], v10 offset:49152
  v_mfma_f32_16x16x32_bf16 v[80:83], v[40:43], v[176:179], v[80:83]
  ds_read_b64_tr_b16 v[62:63], v10 offset:53248
  s_waitcnt lgkmcnt(6)
  v_mfma_f32_16x16x32_bf16 v[84:87], v[44:47], v[172:175], v[84:87]
  s_add_u32 s63, s89, 688128
  s_add_u32 m0, s45, 73728
  ds_read_b64_tr_b16 v[64:65], v11 offset:49152
  buffer_load_dwordx4 v2, s[12:15], s63 offen lds
  v_mfma_f32_16x16x32_bf16 v[88:91], v[44:47], v[176:179], v[88:91]
  ds_read_b64_tr_b16 v[66:67], v11 offset:53248
  v_mfma_f32_16x16x32_bf16 v[92:95], v[48:51], v[172:175], v[92:95]
  s_barrier
  ds_read_b64_tr_b16 v[36:37], v12 offset:32768
  v_mfma_f32_16x16x32_bf16 v[96:99], v[48:51], v[176:179], v[96:99]
  ds_read_b64_tr_b16 v[38:39], v12 offset:36864
  s_waitcnt lgkmcnt(6)
  v_mfma_f32_16x16x32_bf16 v[100:103], v[52:55], v[172:175], v[100:103]
  ds_read_b64_tr_b16 v[40:41], v13 offset:32768
  v_mfma_f32_16x16x32_bf16 v[104:107], v[52:55], v[176:179], v[104:107]
  s_add_u32 s62, s90, 20480
  ds_read_b64_tr_b16 v[42:43], v13 offset:36864
  buffer_load_dwordx4 v[148:151], v27, s[28:31], s62 offen sc1
  v_mfma_f32_16x16x32_bf16 v[108:111], v[56:59], v[172:175], v[108:111]
  ds_read_b64_tr_b16 v[44:45], v14 offset:32768
  v_mfma_f32_16x16x32_bf16 v[112:115], v[56:59], v[176:179], v[112:115]
  ds_read_b64_tr_b16 v[46:47], v14 offset:36864
  s_waitcnt lgkmcnt(6)
  v_mfma_f32_16x16x32_bf16 v[116:119], v[60:63], v[172:175], v[116:119]
  ds_read_b64_tr_b16 v[48:49], v15 offset:32768
  v_mfma_f32_16x16x32_bf16 v[120:123], v[60:63], v[176:179], v[120:123]
  s_add_u32 s63, s91, 20480
  ds_read_b64_tr_b16 v[50:51], v15 offset:36864
  buffer_load_dwordx4 v[152:155], v27, s[28:31], s63 offen sc1
  v_mfma_f32_16x16x32_bf16 v[124:127], v[64:67], v[172:175], v[124:127]
  ds_read_b64_tr_b16 v[52:53], v16 offset:32768
  v_mfma_f32_16x16x32_bf16 v[128:131], v[64:67], v[176:179], v[128:131]
  ds_read_b64_tr_b16 v[54:55], v16 offset:36864
  s_waitcnt vmcnt(14) lgkmcnt(6)
  v_mfma_f32_16x16x32_bf16 v[68:71], v[36:39], v[180:183], v[68:71]
  ds_read_b64_tr_b16 v[56:57], v17 offset:32768
  v_mfma_f32_16x16x32_bf16 v[72:75], v[36:39], v[184:187], v[72:75]
  s_add_u32 s62, s89, 720896
  s_add_u32 m0, s45, 32768
  ds_read_b64_tr_b16 v[58:59], v17 offset:36864
  buffer_load_dwordx4 v2, s[12:15], s62 offen lds
  v_mfma_f32_16x16x32_bf16 v[76:79], v[40:43], v[180:183], v[76:79]
  ds_read_b64_tr_b16 v[60:61], v18 offset:32768
  v_mfma_f32_16x16x32_bf16 v[80:83], v[40:43], v[184:187], v[80:83]
  ds_read_b64_tr_b16 v[62:63], v18 offset:36864
  s_waitcnt lgkmcnt(6)
  v_mfma_f32_16x16x32_bf16 v[84:87], v[44:47], v[180:183], v[84:87]
  ds_read_b64_tr_b16 v[64:65], v19 offset:32768
  v_mfma_f32_16x16x32_bf16 v[88:91], v[44:47], v[184:187], v[88:91]
  ds_read_b64_tr_b16 v[66:67], v19 offset:36864
  v_mfma_f32_16x16x32_bf16 v[92:95], v[48:51], v[180:183], v[92:95]
  s_barrier
  s_add_u32 s63, s89, 753664
  s_add_u32 m0, s45, 40960
  ds_read_b64_tr_b16 v[36:37], v12 offset:49152
  buffer_load_dwordx4 v2, s[12:15], s63 offen lds
  v_mfma_f32_16x16x32_bf16 v[96:99], v[48:51], v[184:187], v[96:99]
  ds_read_b64_tr_b16 v[38:39], v12 offset:53248
  s_waitcnt lgkmcnt(6)
  v_mfma_f32_16x16x32_bf16 v[100:103], v[52:55], v[180:183], v[100:103]
  ds_read_b64_tr_b16 v[40:41], v13 offset:49152
  v_mfma_f32_16x16x32_bf16 v[104:107], v[52:55], v[184:187], v[104:107]
  ds_read_b64_tr_b16 v[42:43], v13 offset:53248
  v_mfma_f32_16x16x32_bf16 v[108:111], v[56:59], v[180:183], v[108:111]
  s_add_u32 s62, s90, 22528
  ds_read_b64_tr_b16 v[44:45], v14 offset:49152
  buffer_load_dwordx4 v[156:159], v27, s[28:31], s62 offen sc1
  v_mfma_f32_16x16x32_bf16 v[112:115], v[56:59], v[184:187], v[112:115]
  ds_read_b64_tr_b16 v[46:47], v14 offset:53248
  s_waitcnt lgkmcnt(6)
  v_mfma_f32_16x16x32_bf16 v[116:119], v[60:63], v[180:183], v[116:119]
  ds_read_b64_tr_b16 v[48:49], v15 offset:49152
  v_mfma_f32_16x16x32_bf16 v[120:123], v[60:63], v[184:187], v[120:123]
  ds_read_b64_tr_b16 v[50:51], v15 offset:53248
  v_mfma_f32_16x16x32_bf16 v[124:127], v[64:67], v[180:183], v[124:127]
  ds_read_b64_tr_b16 v[52:53], v16 offset:49152
  v_mfma_f32_16x16x32_bf16 v[128:131], v[64:67], v[184:187], v[128:131]
  s_add_u32 s63, s91, 22528
  ds_read_b64_tr_b16 v[54:55], v16 offset:53248
  buffer_load_dwordx4 v[160:163], v27, s[28:31], s63 offen sc1
  s_waitcnt vmcnt(16) lgkmcnt(6)
  v_mfma_f32_16x16x32_bf16 v[68:71], v[36:39], v[188:191], v[68:71]
  ds_read_b64_tr_b16 v[56:57], v17 offset:49152
  v_mfma_f32_16x16x32_bf16 v[72:75], v[36:39], v[192:195], v[72:75]
  ds_read_b64_tr_b16 v[58:59], v17 offset:53248
  v_mfma_f32_16x16x32_bf16 v[76:79], v[40:43], v[188:191], v[76:79]
  ds_read_b64_tr_b16 v[60:61], v18 offset:49152
  v_mfma_f32_16x16x32_bf16 v[80:83], v[40:43], v[192:195], v[80:83]
  s_add_u32 s62, s89, 786432
  s_add_u32 m0, s45, 81920
  ds_read_b64_tr_b16 v[62:63], v18 offset:53248
  buffer_load_dwordx4 v2, s[12:15], s62 offen lds
  s_waitcnt lgkmcnt(6)
  v_mfma_f32_16x16x32_bf16 v[84:87], v[44:47], v[188:191], v[84:87]
  ds_read_b64_tr_b16 v[64:65], v19 offset:49152
  v_mfma_f32_16x16x32_bf16 v[88:91], v[44:47], v[192:195], v[88:91]
  ds_read_b64_tr_b16 v[66:67], v19 offset:53248
  v_mfma_f32_16x16x32_bf16 v[92:95], v[48:51], v[188:191], v[92:95]
  s_waitcnt vmcnt(15)
  s_barrier
  ds_read_b64_tr_b16 v[36:37], v4 offset:0
  v_mfma_f32_16x16x32_bf16 v[96:99], v[48:51], v[192:195], v[96:99]
  s_add_u32 s63, s89, 819200
  s_add_u32 m0, s45, 90112
  ds_read_b64_tr_b16 v[38:39], v4 offset:4096
  buffer_load_dwordx4 v2, s[12:15], s63 offen lds
  s_waitcnt lgkmcnt(6)
  v_mfma_f32_16x16x32_bf16 v[100:103], v[52:55], v[188:191], v[100:103]
  ds_read_b64_tr_b16 v[40:41], v5 offset:0
  v_mfma_f32_16x16x32_bf16 v[104:107], v[52:55], v[192:195], v[104:107]
  ds_read_b64_tr_b16 v[42:43], v5 offset:4096
  v_mfma_f32_16x16x32_bf16 v[108:111], v[56:59], v[188:191], v[108:111]
  ds_read_b64_tr_b16 v[44:45], v6 offset:0
  v_mfma_f32_16x16x32_bf16 v[112:115], v[56:59], v[192:195], v[112:115]
  ds_read_b64_tr_b16 v[46:47], v6 offset:4096
  s_waitcnt lgkmcnt(6)
  v_mfma_f32_16x16x32_bf16 v[116:119], v[60:63], v[188:191], v[116:119]
  s_add_u32 s62, s90, 24576
  ds_read_b64_tr_b16 v[48:49], v7 offset:0
  buffer_load_dwordx4 v[164:167], v27, s[28:31], s62 offen sc1
  v_mfma_f32_16x16x32_bf16 v[120:123], v[60:63], v[192:195], v[120:123]
  ds_read_b64_tr_b16 v[50:51], v7 offset:4096
  v_mfma_f32_16x16x32_bf16 v[124:127], v[64:67], v[188:191], v[124:127]
  ds_read_b64_tr_b16 v[52:53], v8 offset:0
  v_mfma_f32_16x16x32_bf16 v[128:131], v[64:67], v[192:195], v[128:131]
  ds_read_b64_tr_b16 v[54:55], v8 offset:4096
  s_waitcnt vmcnt(15) lgkmcnt(6)
  v_mfma_f32_16x16x32_bf16 v[68:71], v[36:39], v[132:135], v[68:71]
  s_add_u32 s63, s91, 24576
  ds_read_b64_tr_b16 v[56:57], v9 offset:0
  buffer_load_dwordx4 v[168:171], v27, s[28:31], s63 offen sc1
  v_mfma_f32_16x16x32_bf16 v[72:75], v[36:39], v[136:139], v[72:75]
  ds_read_b64_tr_b16 v[58:59], v9 offset:4096
  v_mfma_f32_16x16x32_bf16 v[76:79], v[40:43], v[132:135], v[76:79]
  ds_read_b64_tr_b16 v[60:61], v10 offset:0
  v_mfma_f32_16x16x32_bf16 v[80:83], v[40:43], v[136:139], v[80:83]
  ds_read_b64_tr_b16 v[62:63], v10 offset:4096
  s_waitcnt lgkmcnt(6)
  v_mfma_f32_16x16x32_bf16 v[84:87], v[44:47], v[132:135], v[84:87]
  ds_read_b64_tr_b16 v[64:65], v11 offset:0
  v_mfma_f32_16x16x32_bf16 v[88:91], v[44:47], v[136:139], v[88:91]
  s_add_u32 s62, s89, 851968
  s_add_u32 m0, s45, 49152
  ds_read_b64_tr_b16 v[66:67], v11 offset:4096
  buffer_load_dwordx4 v2, s[12:15], s62 offen lds
  v_mfma_f32_16x16x32_bf16 v[92:95], v[48:51], v[132:135], v[92:95]
  s_waitcnt vmcnt(15)
  s_barrier
  ds_read_b64_tr_b16 v[36:37], v4 offset:16384
  v_mfma_f32_16x16x32_bf16 v[96:99], v[48:51], v[136:139], v[96:99]
  ds_read_b64_tr_b16 v[38:39], v4 offset:20480
  s_waitcnt lgkmcnt(6)
  v_mfma_f32_16x16x32_bf16 v[100:103], v[52:55], v[132:135], v[100:103]
  ds_read_b64_tr_b16 v[40:41], v5 offset:16384
  v_mfma_f32_16x16x32_bf16 v[104:107], v[52:55], v[136:139], v[104:107]
  s_add_u32 s63, s89, 884736
  s_add_u32 m0, s45, 57344
  ds_read_b64_tr_b16 v[42:43], v5 offset:20480
  buffer_load_dwordx4 v2, s[12:15], s63 offen lds
  v_mfma_f32_16x16x32_bf16 v[108:111], v[56:59], v[132:135], v[108:111]
  ds_read_b64_tr_b16 v[44:45], v6 offset:16384
  v_mfma_f32_16x16x32_bf16 v[112:115], v[56:59], v[136:139], v[112:115]
  ds_read_b64_tr_b16 v[46:47], v6 offset:20480
  s_waitcnt lgkmcnt(6)
  v_mfma_f32_16x16x32_bf16 v[116:119], v[60:63], v[132:135], v[116:119]
  ds_read_b64_tr_b16 v[48:49], v7 offset:16384
  v_mfma_f32_16x16x32_bf16 v[120:123], v[60:63], v[136:139], v[120:123]
  s_add_u32 s62, s90, 26624
  ds_read_b64_tr_b16 v[50:51], v7 offset:20480
  buffer_load_dwordx4 v[172:175], v27, s[28:31], s62 offen sc1
  v_mfma_f32_16x16x32_bf16 v[124:127], v[64:67], v[132:135], v[124:127]
  ds_read_b64_tr_b16 v[52:53], v8 offset:16384
  v_mfma_f32_16x16x32_bf16 v[128:131], v[64:67], v[136:139], v[128:131]
  ds_read_b64_tr_b16 v[54:55], v8 offset:20480
  s_waitcnt vmcnt(15) lgkmcnt(6)
  v_mfma_f32_16x16x32_bf16 v[68:71], v[36:39], v[140:143], v[68:71]
  ds_read_b64_tr_b16 v[56:57], v9 offset:16384
  v_mfma_f32_16x16x32_bf16 v[72:75], v[36:39], v[144:147], v[72:75]
  ds_read_b64_tr_b16 v[58:59], v9 offset:20480
  v_mfma_f32_16x16x32_bf16 v[76:79], v[40:43], v[140:143], v[76:79]
  s_add_u32 s63, s91, 26624
  ds_read_b64_tr_b16 v[60:61], v10 offset:16384
  buffer_load_dwordx4 v[176:179], v27, s[28:31], s63 offen sc1
  v_mfma_f32_16x16x32_bf16 v[80:83], v[40:43], v[144:147], v[80:83]
  ds_read_b64_tr_b16 v[62:63], v10 offset:20480
  s_waitcnt lgkmcnt(6)
  v_mfma_f32_16x16x32_bf16 v[84:87], v[44:47], v[140:143], v[84:87]
  ds_read_b64_tr_b16 v[64:65], v11 offset:16384
  v_mfma_f32_16x16x32_bf16 v[88:91], v[44:47], v[144:147], v[88:91]
  ds_read_b64_tr_b16 v[66:67], v11 offset:20480
  v_mfma_f32_16x16x32_bf16 v[92:95], v[48:51], v[140:143], v[92:95]
  s_waitcnt vmcnt(14)
  s_barrier
  s_add_u32 s62, s89, 917504
  s_add_u32 m0, s45, 98304
  ds_read_b64_tr_b16 v[36:37], v12 offset:0
  buffer_load_dwordx4 v2, s[12:15], s62 offen lds
  v_mfma_f32_16x16x32_bf16 v[96:99], v[48:51], v[144:147], v[96:99]
  ds_read_b64_tr_b16 v[38:39], v12 offset:4096
  s_waitcnt lgkmcnt(6)
  v_mfma_f32_16x16x32_bf16 v[100:103], v[52:55], v[140:143], v[100:103]
  ds_read_b64_tr_b16 v[40:41], v13 offset:0
  v_mfma_f32_16x16x32_bf16 v[104:107], v[52:55], v[144:147], v[104:107]
  ds_read_b64_tr_b16 v[42:43], v13 offset:4096
  v_mfma_f32_16x16x32_bf16 v[108:111], v[56:59], v[140:143], v[108:111]
  ds_read_b64_tr_b16 v[44:45], v14 offset:0
  v_mfma_f32_16x16x32_bf16 v[112:115], v[56:59], v[144:147], v[112:115]
  s_add_u32 s63, s89, 950272
  s_add_u32 m0, s45, 106496
  ds_read_b64_tr_b16 v[46:47], v14 offset:4096
  buffer_load_dwordx4 v2, s[12:15], s63 offen lds
  s_waitcnt lgkmcnt(6)
  v_mfma_f32_16x16x32_bf16 v[116:119], v[60:63], v[140:143], v[116:119]
  ds_read_b64_tr_b16 v[48:49], v15 offset:0
  v_mfma_f32_16x16x32_bf16 v[120:123], v[60:63], v[144:147], v[120:123]
  ds_read_b64_tr_b16 v[50:51], v15 offset:4096
  v_mfma_f32_16x16x32_bf16 v[124:127], v[64:67], v[140:143], v[124:127]
  ds_read_b64_tr_b16 v[52:53], v16 offset:0
  v_mfma_f32_16x16x32_bf16 v[128:131], v[64:67], v[144:147], v[128:131]
  s_add_u32 s62, s90, 28672
  ds_read_b64_tr_b16 v[54:55], v16 offset:4096
  buffer_load_dwordx4 v[180:183], v27, s[28:31], s62 offen sc1
  s_waitcnt vmcnt(15) lgkmcnt(6)
  v_mfma_f32_16x16x32_bf16 v[68:71], v[36:39], v[148:151], v[68:71]
  ds_read_b64_tr_b16 v[56:57], v17 offset:0
  v_mfma_f32_16x16x32_bf16 v[72:75], v[36:39], v[152:155], v[72:75]
  ds_read_b64_tr_b16 v[58:59], v17 offset:4096
  v_mfma_f32_16x16x32_bf16 v[76:79], v[40:43], v[148:151], v[76:79]
  ds_read_b64_tr_b16 v[60:61], v18 offset:0
  v_mfma_f32_16x16x32_bf16 v[80:83], v[40:43], v[152:155], v[80:83]
  s_add_u32 s63, s91, 28672
  ds_read_b64_tr_b16 v[62:63], v18 offset:4096
  buffer_load_dwordx4 v[184:187], v27, s[28:31], s63 offen sc1
  s_waitcnt lgkmcnt(6)
  v_mfma_f32_16x16x32_bf16 v[84:87], v[44:47], v[148:151], v[84:87]
  ds_read_b64_tr_b16 v[64:65], v19 offset:0
  v_mfma_f32_16x16x32_bf16 v[88:91], v[44:47], v[152:155], v[88:91]
  ds_read_b64_tr_b16 v[66:67], v19 offset:4096
  v_mfma_f32_16x16x32_bf16 v[92:95], v[48:51], v[148:151], v[92:95]
  s_waitcnt vmcnt(14)
  s_barrier
  ds_read_b64_tr_b16 v[36:37], v4 offset:32768
  v_mfma_f32_16x16x32_bf16 v[96:99], v[48:51], v[152:155], v[96:99]
  ds_read_b64_tr_b16 v[38:39], v4 offset:36864
  s_waitcnt lgkmcnt(6)
  v_mfma_f32_16x16x32_bf16 v[100:103], v[52:55], v[148:151], v[100:103]
  s_add_u32 s62, s89, 983040
  s_add_u32 m0, s45, 114688
  ds_read_b64_tr_b16 v[40:41], v5 offset:32768
  buffer_load_dwordx4 v2, s[12:15], s62 offen lds
  v_mfma_f32_16x16x32_bf16 v[104:107], v[52:55], v[152:155], v[104:107]
  ds_read_b64_tr_b16 v[42:43], v5 offset:36864
  v_mfma_f32_16x16x32_bf16 v[108:111], v[56:59], v[148:151], v[108:111]
  ds_read_b64_tr_b16 v[44:45], v6 offset:32768
  v_mfma_f32_16x16x32_bf16 v[112:115], v[56:59], v[152:155], v[112:115]
  ds_read_b64_tr_b16 v[46:47], v6 offset:36864
  s_waitcnt lgkmcnt(6)
  v_mfma_f32_16x16x32_bf16 v[116:119], v[60:63], v[148:151], v[116:119]
  s_add_u32 s63, s89, 1015808
  s_add_u32 m0, s45, 122880
  ds_read_b64_tr_b16 v[48:49], v7 offset:32768
  buffer_load_dwordx4 v2, s[12:15], s63 offen lds
  v_mfma_f32_16x16x32_bf16 v[120:123], v[60:63], v[152:155], v[120:123]
  ds_read_b64_tr_b16 v[50:51], v7 offset:36864
  v_mfma_f32_16x16x32_bf16 v[124:127], v[64:67], v[148:151], v[124:127]
  ds_read_b64_tr_b16 v[52:53], v8 offset:32768
  v_mfma_f32_16x16x32_bf16 v[128:131], v[64:67], v[152:155], v[128:131]
  ds_read_b64_tr_b16 v[54:55], v8 offset:36864
  s_waitcnt vmcnt(14) lgkmcnt(6)
  v_mfma_f32_16x16x32_bf16 v[68:71], v[36:39], v[156:159], v[68:71]
  ds_read_b64_tr_b16 v[56:57], v9 offset:32768
  v_mfma_f32_16x16x32_bf16 v[72:75], v[36:39], v[160:163], v[72:75]
  s_add_u32 s62, s90, 30720
  ds_read_b64_tr_b16 v[58:59], v9 offset:36864
  buffer_load_dwordx4 v[188:191], v27, s[28:31], s62 offen sc1
  v_mfma_f32_16x16x32_bf16 v[76:79], v[40:43], v[156:159], v[76:79]
  ds_read_b64_tr_b16 v[60:61], v10 offset:32768
  v_mfma_f32_16x16x32_bf16 v[80:83], v[40:43], v[160:163], v[80:83]
  ds_read_b64_tr_b16 v[62:63], v10 offset:36864
  s_waitcnt lgkmcnt(6)
  v_mfma_f32_16x16x32_bf16 v[84:87], v[44:47], v[156:159], v[84:87]
  ds_read_b64_tr_b16 v[64:65], v11 offset:32768
  v_mfma_f32_16x16x32_bf16 v[88:91], v[44:47], v[160:163], v[88:91]
  s_add_u32 s63, s91, 30720
  ds_read_b64_tr_b16 v[66:67], v11 offset:36864
  buffer_load_dwordx4 v[192:195], v27, s[28:31], s63 offen sc1
  v_mfma_f32_16x16x32_bf16 v[92:95], v[48:51], v[156:159], v[92:95]
  s_waitcnt vmcnt(14)
  s_barrier
  ds_read_b64_tr_b16 v[36:37], v12 offset:16384
  v_mfma_f32_16x16x32_bf16 v[96:99], v[48:51], v[160:163], v[96:99]
  ds_read_b64_tr_b16 v[38:39], v12 offset:20480
  s_waitcnt lgkmcnt(6)
  v_mfma_f32_16x16x32_bf16 v[100:103], v[52:55], v[156:159], v[100:103]
  ds_read_b64_tr_b16 v[40:41], v13 offset:16384
  v_mfma_f32_16x16x32_bf16 v[104:107], v[52:55], v[160:163], v[104:107]
  s_add_u32 s62, s89, 1048576
  s_add_u32 m0, s45, 0
  ds_read_b64_tr_b16 v[42:43], v13 offset:20480
  buffer_load_dwordx4 v2, s[12:15], s62 offen lds
  v_mfma_f32_16x16x32_bf16 v[108:111], v[56:59], v[156:159], v[108:111]
  ds_read_b64_tr_b16 v[44:45], v14 offset:16384
  v_mfma_f32_16x16x32_bf16 v[112:115], v[56:59], v[160:163], v[112:115]
  ds_read_b64_tr_b16 v[46:47], v14 offset:20480
  s_waitcnt lgkmcnt(6)
  v_mfma_f32_16x16x32_bf16 v[116:119], v[60:63], v[156:159], v[116:119]
  ds_read_b64_tr_b16 v[48:49], v15 offset:16384
  v_mfma_f32_16x16x32_bf16 v[120:123], v[60:63], v[160:163], v[120:123]
  ds_read_b64_tr_b16 v[50:51], v15 offset:20480
  v_mfma_f32_16x16x32_bf16 v[124:127], v[64:67], v[156:159], v[124:127]
  s_add_u32 s63, s89, 1081344
  s_add_u32 m0, s45, 8192
  ds_read_b64_tr_b16 v[52:53], v16 offset:16384
  buffer_load_dwordx4 v2, s[12:15], s63 offen lds
  v_mfma_f32_16x16x32_bf16 v[128:131], v[64:67], v[160:163], v[128:131]
  ds_read_b64_tr_b16 v[54:55], v16 offset:20480
  s_waitcnt vmcnt(14) lgkmcnt(6)
  v_mfma_f32_16x16x32_bf16 v[68:71], v[36:39], v[164:167], v[68:71]
  ds_read_b64_tr_b16 v[56:57], v17 offset:16384
  v_mfma_f32_16x16x32_bf16 v[72:75], v[36:39], v[168:171], v[72:75]
  ds_read_b64_tr_b16 v[58:59], v17 offset:20480
  v_mfma_f32_16x16x32_bf16 v[76:79], v[40:43], v[164:167], v[76:79]
  s_add_u32 s62, s90, 32768
  ds_read_b64_tr_b16 v[60:61], v18 offset:16384
  buffer_load_dwordx4 v[132:135], v27, s[28:31], s62 offen sc1
  v_mfma_f32_16x16x32_bf16 v[80:83], v[40:43], v[168:171], v[80:83]
  ds_read_b64_tr_b16 v[62:63], v18 offset:20480
  s_waitcnt lgkmcnt(6)
  v_mfma_f32_16x16x32_bf16 v[84:87], v[44:47], v[164:167], v[84:87]
  ds_read_b64_tr_b16 v[64:65], v19 offset:16384
  v_mfma_f32_16x16x32_bf16 v[88:91], v[44:47], v[168:171], v[88:91]
  ds_read_b64_tr_b16 v[66:67], v19 offset:20480
  v_mfma_f32_16x16x32_bf16 v[92:95], v[48:51], v[164:167], v[92:95]
  s_waitcnt vmcnt(13)
  s_barrier
  ds_read_b64_tr_b16 v[36:37], v4 offset:49152
  v_mfma_f32_16x16x32_bf16 v[96:99], v[48:51], v[168:171], v[96:99]
  s_add_u32 s63, s91, 32768
  ds_read_b64_tr_b16 v[38:39], v4 offset:53248
  buffer_load_dwordx4 v[136:139], v27, s[28:31], s63 offen sc1
  s_waitcnt lgkmcnt(6)
  v_mfma_f32_16x16x32_bf16 v[100:103], v[52:55], v[164:167], v[100:103]
  ds_read_b64_tr_b16 v[40:41], v5 offset:49152
  v_mfma_f32_16x16x32_bf16 v[104:107], v[52:55], v[168:171], v[104:107]
  ds_read_b64_tr_b16 v[42:43], v5 offset:53248
  v_mfma_f32_16x16x32_bf16 v[108:111], v[56:59], v[164:167], v[108:111]
  ds_read_b64_tr_b16 v[44:45], v6 offset:49152
  v_mfma_f32_16x16x32_bf16 v[112:115], v[56:59], v[168:171], v[112:115]
  s_add_u32 s62, s89, 1114112
  s_add_u32 m0, s45, 16384
  ds_read_b64_tr_b16 v[46:47], v6 offset:53248
  buffer_load_dwordx4 v2, s[12:15], s62 offen lds
  s_waitcnt lgkmcnt(6)
  v_mfma_f32_16x16x32_bf16 v[116:119], v[60:63], v[164:167], v[116:119]
  ds_read_b64_tr_b16 v[48:49], v7 offset:49152
  v_mfma_f32_16x16x32_bf16 v[120:123], v[60:63], v[168:171], v[120:123]
  ds_read_b64_tr_b16 v[50:51], v7 offset:53248
  v_mfma_f32_16x16x32_bf16 v[124:127], v[64:67], v[164:167], v[124:127]
  ds_read_b64_tr_b16 v[52:53], v8 offset:49152
  v_mfma_f32_16x16x32_bf16 v[128:131], v[64:67], v[168:171], v[128:131]
  s_add_u32 s63, s89, 1146880
  s_add_u32 m0, s45, 24576
  ds_read_b64_tr_b16 v[54:55], v8 offset:53248
  buffer_load_dwordx4 v2, s[12:15], s63 offen lds
  s_waitcnt vmcnt(14) lgkmcnt(6)
  v_mfma_f32_16x16x32_bf16 v[68:71], v[36:39], v[172:175], v[68:71]
  ds_read_b64_tr_b16 v[56:57], v9 offset:49152
  v_mfma_f32_16x16x32_bf16 v[72:75], v[36:39], v[176:179], v[72:75]
  ds_read_b64_tr_b16 v[58:59], v9 offset:53248
  v_mfma_f32_16x16x32_bf16 v[76:79], v[40:43], v[172:175], v[76:79]
  ds_read_b64_tr_b16 v[60:61], v10 offset:49152
  v_mfma_f32_16x16x32_bf16 v[80:83], v[40:43], v[176:179], v[80:83]
  ds_read_b64_tr_b16 v[62:63], v10 offset:53248
  s_waitcnt lgkmcnt(6)
  v_mfma_f32_16x16x32_bf16 v[84:87], v[44:47], v[172:175], v[84:87]
  s_add_u32 s62, s90, 34816
  ds_read_b64_tr_b16 v[64:65], v11 offset:49152
  buffer_load_dwordx4 v[140:143], v27, s[28:31], s62 offen sc1
  v_mfma_f32_16x16x32_bf16 v[88:91], v[44:47], v[176:179], v[88:91]
  ds_read_b64_tr_b16 v[66:67], v11 offset:53248
  v_mfma_f32_16x16x32_bf16 v[92:95], v[48:51], v[172:175], v[92:95]
  s_waitcnt vmcnt(13)
  s_barrier
  ds_read_b64_tr_b16 v[36:37], v12 offset:32768
  v_mfma_f32_16x16x32_bf16 v[96:99], v[48:51], v[176:179], v[96:99]
  ds_read_b64_tr_b16 v[38:39], v12 offset:36864
  s_waitcnt lgkmcnt(6)
  v_mfma_f32_16x16x32_bf16 v[100:103], v[52:55], v[172:175], v[100:103]
  s_add_u32 s63, s91, 34816
  ds_read_b64_tr_b16 v[40:41], v13 offset:32768
  buffer_load_dwordx4 v[144:147], v27, s[28:31], s63 offen sc1
  v_mfma_f32_16x16x32_bf16 v[104:107], v[52:55], v[176:179], v[104:107]
  ds_read_b64_tr_b16 v[42:43], v13 offset:36864
  v_mfma_f32_16x16x32_bf16 v[108:111], v[56:59], v[172:175], v[108:111]
  ds_read_b64_tr_b16 v[44:45], v14 offset:32768
  v_mfma_f32_16x16x32_bf16 v[112:115], v[56:59], v[176:179], v[112:115]
  ds_read_b64_tr_b16 v[46:47], v14 offset:36864
  s_waitcnt lgkmcnt(6)
  v_mfma_f32_16x16x32_bf16 v[116:119], v[60:63], v[172:175], v[116:119]
  ds_read_b64_tr_b16 v[48:49], v15 offset:32768
  v_mfma_f32_16x16x32_bf16 v[120:123], v[60:63], v[176:179], v[120:123]
  s_add_u32 s62, s89, 1179648
  s_add_u32 m0, s45, 65536
  ds_read_b64_tr_b16 v[50:51], v15 offset:36864
  buffer_load_dwordx4 v2, s[12:15], s62 offen lds
  v_mfma_f32_16x16x32_bf16 v[124:127], v[64:67], v[172:175], v[124:127]
  ds_read_b64_tr_b16 v[52:53], v16 offset:32768
  v_mfma_f32_16x16x32_bf16 v[128:131], v[64:67], v[176:179], v[128:131]
  ds_read_b64_tr_b16 v[54:55], v16 offset:36864
  s_waitcnt vmcnt(13) lgkmcnt(6)
  v_mfma_f32_16x16x32_bf16 v[68:71], v[36:39], v[180:183], v[68:71]
  ds_read_b64_tr_b16 v[56:57], v17 offset:32768
  v_mfma_f32_16x16x32_bf16 v[72:75], v[36:39], v[184:187], v[72:75]
  s_add_u32 s63, s89, 1212416
  s_add_u32 m0, s45, 73728
  ds_read_b64_tr_b16 v[58:59], v17 offset:36864
  buffer_load_dwordx4 v2, s[12:15], s63 offen lds
  v_mfma_f32_16x16x32_bf16 v[76:79], v[40:43], v[180:183], v[76:79]
  ds_read_b64_tr_b16 v[60:61], v18 offset:32768
  v_mfma_f32_16x16x32_bf16 v[80:83], v[40:43], v[184:187], v[80:83]
  ds_read_b64_tr_b16 v[62:63], v18 offset:36864
  s_waitcnt lgkmcnt(6)
  v_mfma_f32_16x16x32_bf16 v[84:87], v[44:47], v[180:183], v[84:87]
  ds_read_b64_tr_b16 v[64:65], v19 offset:32768
  v_mfma_f32_16x16x32_bf16 v[88:91], v[44:47], v[184:187], v[88:91]
  s_add_u32 s62, s90, 36864
  ds_read_b64_tr_b16 v[66:67], v19 offset:36864
  buffer_load_dwordx4 v[148:151], v27, s[28:31], s62 offen sc1
  v_mfma_f32_16x16x32_bf16 v[92:95], v[48:51], v[180:183], v[92:95]
  s_waitcnt vmcnt(13)
  s_barrier
  ds_read_b64_tr_b16 v[36:37], v12 offset:49152
  v_mfma_f32_16x16x32_bf16 v[96:99], v[48:51], v[184:187], v[96:99]
  ds_read_b64_tr_b16 v[38:39], v12 offset:53248
  s_waitcnt lgkmcnt(6)
  v_mfma_f32_16x16x32_bf16 v[100:103], v[52:55], v[180:183], v[100:103]
  ds_read_b64_tr_b16 v[40:41], v13 offset:49152
  v_mfma_f32_16x16x32_bf16 v[104:107], v[52:55], v[184:187], v[104:107]
  ds_read_b64_tr_b16 v[42:43], v13 offset:53248
  v_mfma_f32_16x16x32_bf16 v[108:111], v[56:59], v[180:183], v[108:111]
  s_add_u32 s63, s91, 36864
  ds_read_b64_tr_b16 v[44:45], v14 offset:49152
  buffer_load_dwordx4 v[152:155], v27, s[28:31], s63 offen sc1
  v_mfma_f32_16x16x32_bf16 v[112:115], v[56:59], v[184:187], v[112:115]
  ds_read_b64_tr_b16 v[46:47], v14 offset:53248
  s_waitcnt lgkmcnt(6)
  v_mfma_f32_16x16x32_bf16 v[116:119], v[60:63], v[180:183], v[116:119]
  ds_read_b64_tr_b16 v[48:49], v15 offset:49152
  v_mfma_f32_16x16x32_bf16 v[120:123], v[60:63], v[184:187], v[120:123]
  ds_read_b64_tr_b16 v[50:51], v15 offset:53248
  v_mfma_f32_16x16x32_bf16 v[124:127], v[64:67], v[180:183], v[124:127]
  s_add_u32 s62, s89, 1245184
  s_add_u32 m0, s45, 32768
  ds_read_b64_tr_b16 v[52:53], v16 offset:49152
  buffer_load_dwordx4 v2, s[12:15], s62 offen lds
  v_mfma_f32_16x16x32_bf16 v[128:131], v[64:67], v[184:187], v[128:131]
  ds_read_b64_tr_b16 v[54:55], v16 offset:53248
  s_waitcnt vmcnt(13) lgkmcnt(6)
  v_mfma_f32_16x16x32_bf16 v[68:71], v[36:39], v[188:191], v[68:71]
  ds_read_b64_tr_b16 v[56:57], v17 offset:49152
  v_mfma_f32_16x16x32_bf16 v[72:75], v[36:39], v[192:195], v[72:75]
  ds_read_b64_tr_b16 v[58:59], v17 offset:53248
  v_mfma_f32_16x16x32_bf16 v[76:79], v[40:43], v[188:191], v[76:79]
  ds_read_b64_tr_b16 v[60:61], v18 offset:49152
  v_mfma_f32_16x16x32_bf16 v[80:83], v[40:43], v[192:195], v[80:83]
  s_add_u32 s63, s89, 1277952
  s_add_u32 m0, s45, 40960
  ds_read_b64_tr_b16 v[62:63], v18 offset:53248
  buffer_load_dwordx4 v2, s[12:15], s63 offen lds
  s_waitcnt lgkmcnt(6)
  v_mfma_f32_16x16x32_bf16 v[84:87], v[44:47], v[188:191], v[84:87]
  ds_read_b64_tr_b16 v[64:65], v19 offset:49152
  v_mfma_f32_16x16x32_bf16 v[88:91], v[44:47], v[192:195], v[88:91]
  ds_read_b64_tr_b16 v[66:67], v19 offset:53248
  v_mfma_f32_16x16x32_bf16 v[92:95], v[48:51], v[188:191], v[92:95]
  s_waitcnt vmcnt(12)
  s_barrier
  ds_read_b64_tr_b16 v[36:37], v4 offset:0
  v_mfma_f32_16x16x32_bf16 v[96:99], v[48:51], v[192:195], v[96:99]
  s_add_u32 s62, s90, 38912
  ds_read_b64_tr_b16 v[38:39], v4 offset:4096
  buffer_load_dwordx4 v[156:159], v27, s[28:31], s62 offen sc1
  s_waitcnt lgkmcnt(6)
  v_mfma_f32_16x16x32_bf16 v[100:103], v[52:55], v[188:191], v[100:103]
  ds_read_b64_tr_b16 v[40:41], v5 offset:0
  v_mfma_f32_16x16x32_bf16 v[104:107], v[52:55], v[192:195], v[104:107]
  ds_read_b64_tr_b16 v[42:43], v5 offset:4096
  v_mfma_f32_16x16x32_bf16 v[108:111], v[56:59], v[188:191], v[108:111]
  ds_read_b64_tr_b16 v[44:45], v6 offset:0
  v_mfma_f32_16x16x32_bf16 v[112:115], v[56:59], v[192:195], v[112:115]
  s_add_u32 s63, s91, 38912
  ds_read_b64_tr_b16 v[46:47], v6 offset:4096
  buffer_load_dwordx4 v[160:163], v27, s[28:31], s63 offen sc1
  s_waitcnt lgkmcnt(6)
  v_mfma_f32_16x16x32_bf16 v[116:119], v[60:63], v[188:191], v[116:119]
  ds_read_b64_tr_b16 v[48:49], v7 offset:0
  v_mfma_f32_16x16x32_bf16 v[120:123], v[60:63], v[192:195], v[120:123]
  ds_read_b64_tr_b16 v[50:51], v7 offset:4096
  v_mfma_f32_16x16x32_bf16 v[124:127], v[64:67], v[188:191], v[124:127]
  ds_read_b64_tr_b16 v[52:53], v8 offset:0
  v_mfma_f32_16x16x32_bf16 v[128:131], v[64:67], v[192:195], v[128:131]
  ds_read_b64_tr_b16 v[54:55], v8 offset:4096
  s_waitcnt vmcnt(12) lgkmcnt(6)
  v_mfma_f32_16x16x32_bf16 v[68:71], v[36:39], v[132:135], v[68:71]
  s_add_u32 s62, s89, 1310720
  s_add_u32 m0, s45, 81920
  ds_read_b64_tr_b16 v[56:57], v9 offset:0
  buffer_load_dwordx4 v2, s[12:15], s62 offen lds
  v_mfma_f32_16x16x32_bf16 v[72:75], v[36:39], v[136:139], v[72:75]
  ds_read_b64_tr_b16 v[58:59], v9 offset:4096
  v_mfma_f32_16x16x32_bf16 v[76:79], v[40:43], v[132:135], v[76:79]
  ds_read_b64_tr_b16 v[60:61], v10 offset:0
  v_mfma_f32_16x16x32_bf16 v[80:83], v[40:43], v[136:139], v[80:83]
  ds_read_b64_tr_b16 v[62:63], v10 offset:4096
  s_waitcnt lgkmcnt(6)
  v_mfma_f32_16x16x32_bf16 v[84:87], v[44:47], v[132:135], v[84:87]
  s_add_u32 s63, s89, 1343488
  s_add_u32 m0, s45, 90112
  ds_read_b64_tr_b16 v[64:65], v11 offset:0
  buffer_load_dwordx4 v2, s[12:15], s63 offen lds
  v_mfma_f32_16x16x32_bf16 v[88:91], v[44:47], v[136:139], v[88:91]
  ds_read_b64_tr_b16 v[66:67], v11 offset:4096
  v_mfma_f32_16x16x32_bf16 v[92:95], v[48:51], v[132:135], v[92:95]
  s_waitcnt vmcnt(12)
  s_barrier
  ds_read_b64_tr_b16 v[36:37], v4 offset:16384
  v_mfma_f32_16x16x32_bf16 v[96:99], v[48:51], v[136:139], v[96:99]
  ds_read_b64_tr_b16 v[38:39], v4 offset:20480
  s_waitcnt lgkmcnt(6)
  v_mfma_f32_16x16x32_bf16 v[100:103], v[52:55], v[132:135], v[100:103]
  ds_read_b64_tr_b16 v[40:41], v5 offset:16384
  v_mfma_f32_16x16x32_bf16 v[104:107], v[52:55], v[136:139], v[104:107]
  s_add_u32 s62, s90, s82
  s_add_u32 s62, s62, 38912
  ds_read_b64_tr_b16 v[42:43], v5 offset:20480
  buffer_load_dwordx4 v[228:231], v27, s[28:31], s62 offen sc1
  v_mfma_f32_16x16x32_bf16 v[108:111], v[56:59], v[132:135], v[108:111]
  ds_read_b64_tr_b16 v[44:45], v6 offset:16384
  v_mfma_f32_16x16x32_bf16 v[112:115], v[56:59], v[136:139], v[112:115]
  ds_read_b64_tr_b16 v[46:47], v6 offset:20480
  s_waitcnt lgkmcnt(6)
  v_mfma_f32_16x16x32_bf16 v[116:119], v[60:63], v[132:135], v[116:119]
  ds_read_b64_tr_b16 v[48:49], v7 offset:16384
  v_mfma_f32_16x16x32_bf16 v[120:123], v[60:63], v[136:139], v[120:123]
  s_add_u32 s63, s91, s82
  s_add_u32 s63, s63, 38912
  ds_read_b64_tr_b16 v[50:51], v7 offset:20480
  buffer_load_dwordx4 v[232:235], v27, s[28:31], s63 offen sc1
  v_mfma_f32_16x16x32_bf16 v[124:127], v[64:67], v[132:135], v[124:127]
  ds_read_b64_tr_b16 v[52:53], v8 offset:16384
  v_mfma_f32_16x16x32_bf16 v[128:131], v[64:67], v[136:139], v[128:131]
  ds_read_b64_tr_b16 v[54:55], v8 offset:20480
  s_waitcnt vmcnt(12) lgkmcnt(6)
  v_mfma_f32_16x16x32_bf16 v[68:71], v[36:39], v[140:143], v[68:71]
  ds_read_b64_tr_b16 v[56:57], v9 offset:16384
  v_mfma_f32_16x16x32_bf16 v[72:75], v[36:39], v[144:147], v[72:75]
  s_add_u32 s62, s90, 40960
  ds_read_b64_tr_b16 v[58:59], v9 offset:20480
  buffer_load_dwordx4 v[164:167], v27, s[28:31], s62 offen sc1
  v_mfma_f32_16x16x32_bf16 v[76:79], v[40:43], v[140:143], v[76:79]
  ds_read_b64_tr_b16 v[60:61], v10 offset:16384
  v_mfma_f32_16x16x32_bf16 v[80:83], v[40:43], v[144:147], v[80:83]
  ds_read_b64_tr_b16 v[62:63], v10 offset:20480
  s_waitcnt lgkmcnt(6)
  v_mfma_f32_16x16x32_bf16 v[84:87], v[44:47], v[140:143], v[84:87]
  ds_read_b64_tr_b16 v[64:65], v11 offset:16384
  v_mfma_f32_16x16x32_bf16 v[88:91], v[44:47], v[144:147], v[88:91]
  ds_read_b64_tr_b16 v[66:67], v11 offset:20480
  v_mfma_f32_16x16x32_bf16 v[92:95], v[48:51], v[140:143], v[92:95]
  s_waitcnt vmcnt(11)
  s_barrier
  s_add_u32 s63, s91, 40960
  ds_read_b64_tr_b16 v[36:37], v12 offset:0
  buffer_load_dwordx4 v[168:171], v27, s[28:31], s63 offen sc1
  v_mfma_f32_16x16x32_bf16 v[96:99], v[48:51], v[144:147], v[96:99]
  ds_read_b64_tr_b16 v[38:39], v12 offset:4096
  s_waitcnt lgkmcnt(6)
  v_mfma_f32_16x16x32_bf16 v[100:103], v[52:55], v[140:143], v[100:103]
  ds_read_b64_tr_b16 v[40:41], v13 offset:0
  v_mfma_f32_16x16x32_bf16 v[104:107], v[52:55], v[144:147], v[104:107]
  ds_read_b64_tr_b16 v[42:43], v13 offset:4096
  v_mfma_f32_16x16x32_bf16 v[108:111], v[56:59], v[140:143], v[108:111]
  s_add_u32 s62, s89, 1376256
  s_add_u32 m0, s45, 49152
  ds_read_b64_tr_b16 v[44:45], v14 offset:0
  buffer_load_dwordx4 v2, s[12:15], s62 offen lds
  v_mfma_f32_16x16x32_bf16 v[112:115], v[56:59], v[144:147], v[112:115]
  ds_read_b64_tr_b16 v[46:47], v14 offset:4096
  s_waitcnt lgkmcnt(6)
  v_mfma_f32_16x16x32_bf16 v[116:119], v[60:63], v[140:143], v[116:119]
  ds_read_b64_tr_b16 v[48:49], v15 offset:0
  v_mfma_f32_16x16x32_bf16 v[120:123], v[60:63], v[144:147], v[120:123]
  ds_read_b64_tr_b16 v[50:51], v15 offset:4096
  v_mfma_f32_16x16x32_bf16 v[124:127], v[64:67], v[140:143], v[124:127]
  ds_read_b64_tr_b16 v[52:53], v16 offset:0
  v_mfma_f32_16x16x32_bf16 v[128:131], v[64:67], v[144:147], v[128:131]
  s_add_u32 s63, s89, 1376256
  s_add_u32 m0, s45, 57344
  ds_read_b64_tr_b16 v[54:55], v16 offset:4096
  buffer_load_dwordx4 v2, s[12:15], s63 offen lds
  s_waitcnt vmcnt(12) lgkmcnt(6)
  v_mfma_f32_16x16x32_bf16 v[68:71], v[36:39], v[148:151], v[68:71]
  ds_read_b64_tr_b16 v[56:57], v17 offset:0
  v_mfma_f32_16x16x32_bf16 v[72:75], v[36:39], v[152:155], v[72:75]
  ds_read_b64_tr_b16 v[58:59], v17 offset:4096
  v_mfma_f32_16x16x32_bf16 v[76:79], v[40:43], v[148:151], v[76:79]
  ds_read_b64_tr_b16 v[60:61], v18 offset:0
  v_mfma_f32_16x16x32_bf16 v[80:83], v[40:43], v[152:155], v[80:83]
  s_add_u32 s62, s90, s82
  s_add_u32 s62, s62, 40960
  ds_read_b64_tr_b16 v[62:63], v18 offset:4096
  buffer_load_dwordx4 v[236:239], v27, s[28:31], s62 offen sc1
  s_waitcnt lgkmcnt(6)
  v_mfma_f32_16x16x32_bf16 v[84:87], v[44:47], v[148:151], v[84:87]
  ds_read_b64_tr_b16 v[64:65], v19 offset:0
  v_mfma_f32_16x16x32_bf16 v[88:91], v[44:47], v[152:155], v[88:91]
  ds_read_b64_tr_b16 v[66:67], v19 offset:4096
  v_mfma_f32_16x16x32_bf16 v[92:95], v[48:51], v[148:151], v[92:95]
  s_waitcnt vmcnt(11)
  s_barrier
  ds_read_b64_tr_b16 v[36:37], v4 offset:32768
  v_mfma_f32_16x16x32_bf16 v[96:99], v[48:51], v[152:155], v[96:99]
  s_add_u32 s63, s91, s82
  s_add_u32 s63, s63, 40960
  ds_read_b64_tr_b16 v[38:39], v4 offset:36864
  buffer_load_dwordx4 v[240:243], v27, s[28:31], s63 offen sc1
  s_waitcnt lgkmcnt(6)
  v_mfma_f32_16x16x32_bf16 v[100:103], v[52:55], v[148:151], v[100:103]
  ds_read_b64_tr_b16 v[40:41], v5 offset:32768
  v_mfma_f32_16x16x32_bf16 v[104:107], v[52:55], v[152:155], v[104:107]
  ds_read_b64_tr_b16 v[42:43], v5 offset:36864
  v_mfma_f32_16x16x32_bf16 v[108:111], v[56:59], v[148:151], v[108:111]
  ds_read_b64_tr_b16 v[44:45], v6 offset:32768
  v_mfma_f32_16x16x32_bf16 v[112:115], v[56:59], v[152:155], v[112:115]
  ds_read_b64_tr_b16 v[46:47], v6 offset:36864
  s_waitcnt lgkmcnt(6)
  v_mfma_f32_16x16x32_bf16 v[116:119], v[60:63], v[148:151], v[116:119]
  s_add_u32 s62, s90, s92
  ds_read_b64_tr_b16 v[48:49], v7 offset:32768
  buffer_load_dwordx4 v[172:175], v27, s[28:31], s62 offen sc1
  v_mfma_f32_16x16x32_bf16 v[120:123], v[60:63], v[152:155], v[120:123]
  ds_read_b64_tr_b16 v[50:51], v7 offset:36864
  v_mfma_f32_16x16x32_bf16 v[124:127], v[64:67], v[148:151], v[124:127]
  ds_read_b64_tr_b16 v[52:53], v220 offset:32768
  v_mfma_f32_16x16x32_bf16 v[128:131], v[64:67], v[152:155], v[128:131]
  ds_read_b64_tr_b16 v[54:55], v220 offset:36864
  s_waitcnt vmcnt(11) lgkmcnt(6)
  v_mfma_f32_16x16x32_bf16 v[68:71], v[36:39], v[156:159], v[68:71]
  s_add_u32 s63, s91, s92
  ds_read_b64_tr_b16 v[56:57], v221 offset:32768
  buffer_load_dwordx4 v[176:179], v27, s[28:31], s63 offen sc1
  v_mfma_f32_16x16x32_bf16 v[72:75], v[36:39], v[160:163], v[72:75]
  ds_read_b64_tr_b16 v[58:59], v221 offset:36864
  v_mfma_f32_16x16x32_bf16 v[76:79], v[40:43], v[156:159], v[76:79]
  ds_read_b64_tr_b16 v[60:61], v222 offset:32768
  ds_write_b128 v20, v[100:103] offset:0
  v_mfma_f32_16x16x32_bf16 v[80:83], v[40:43], v[160:163], v[80:83]
  ds_read_b64_tr_b16 v[62:63], v222 offset:36864
  ds_write_b128 v20, v[104:107] offset:1024
  s_waitcnt lgkmcnt(8)
  v_mfma_f32_16x16x32_bf16 v[84:87], v[44:47], v[156:159], v[84:87]
  ds_read_b64_tr_b16 v[64:65], v223 offset:32768
  buffer_load_dwordx4 v[196:199], v3, s[8:11], s68 offen
  ds_write_b128 v20, v[108:111] offset:2048
  v_mfma_f32_16x16x32_bf16 v[88:91], v[44:47], v[160:163], v[88:91]
  ds_read_b64_tr_b16 v[66:67], v223 offset:36864
  ds_write_b128 v20, v[112:115] offset:3072
  v_mfma_f32_16x16x32_bf16 v[92:95], v[48:51], v[156:159], v[92:95]
  s_waitcnt vmcnt(11)
  s_barrier
  ds_read_b64_tr_b16 v[36:37], v12 offset:16384
  ds_write_b128 v20, v[116:119] offset:4096
  v_mfma_f32_16x16x32_bf16 v[96:99], v[48:51], v[160:163], v[96:99]
  ds_read_b64_tr_b16 v[38:39], v12 offset:20480
  buffer_load_dwordx2 v[200:201], v35, s[16:19], s69 offen
  ds_write_b128 v20, v[120:123] offset:5120
  s_waitcnt vmcnt(10) lgkmcnt(12)
  v_mfma_f32_16x16x32_bf16 v[68:71], v[52:55], v[228:231], v[68:71]
  ds_read_b64_tr_b16 v[40:41], v13 offset:16384
  ds_write_b128 v20, v[124:127] offset:6144
  v_mfma_f32_16x16x32_bf16 v[72:75], v[52:55], v[232:235], v[72:75]
  ds_read_b64_tr_b16 v[42:43], v13 offset:20480
  ds_write_b128 v20, v[128:131] offset:7168
  v_mfma_f32_16x16x32_bf16 v[76:79], v[56:59], v[228:231], v[76:79]
  ds_read_b64_tr_b16 v[44:45], v14 offset:16384
  buffer_load_dwordx2 v[202:203], v35, s[16:19], s69 offen offset:32
  v_mfma_f32_16x16x32_bf16 v[80:83], v[56:59], v[232:235], v[80:83]
  ds_read_b64_tr_b16 v[46:47], v14 offset:20480
  s_waitcnt lgkmcnt(11)
  v_mfma_f32_16x16x32_bf16 v[84:87], v[60:63], v[228:231], v[84:87]
  ds_read_b64_tr_b16 v[48:49], v15 offset:16384
  v_mfma_f32_16x16x32_bf16 v[88:91], v[60:63], v[232:235], v[88:91]
  ds_read_b64_tr_b16 v[50:51], v15 offset:20480
  v_mfma_f32_16x16x32_bf16 v[92:95], v[64:67], v[228:231], v[92:95]
  ds_read_b64_tr_b16 v[52:53], v224 offset:16384
  v_mfma_f32_16x16x32_bf16 v[96:99], v[64:67], v[232:235], v[96:99]
  ds_read_b64_tr_b16 v[54:55], v224 offset:20480
  s_waitcnt lgkmcnt(6)
  s_barrier
  s_waitcnt vmcnt(9)
  v_mfma_f32_16x16x32_bf16 v[68:71], v[36:39], v[164:167], v[68:71]
  ds_read_b64_tr_b16 v[56:57], v225 offset:16384
  ds_read_b128 v[180:183], v21 offset:0
  v_mfma_f32_16x16x32_bf16 v[72:75], v[36:39], v[168:171], v[72:75]
  ds_read_b64_tr_b16 v[58:59], v225 offset:20480
  ds_read_b128 v[184:187], v21 offset:1024
  v_mfma_f32_16x16x32_bf16 v[76:79], v[40:43], v[164:167], v[76:79]
  ds_read_b64_tr_b16 v[60:61], v226 offset:16384
  ds_read_b128 v[188:191], v21 offset:2048
  v_mfma_f32_16x16x32_bf16 v[80:83], v[40:43], v[168:171], v[80:83]
  ds_read_b64_tr_b16 v[62:63], v226 offset:20480
  ds_read_b128 v[192:195], v21 offset:3072
  s_waitcnt lgkmcnt(10)
  v_mfma_f32_16x16x32_bf16 v[84:87], v[44:47], v[164:167], v[84:87]
  ds_read_b64_tr_b16 v[64:65], v227 offset:16384
  ds_read_b128 v[132:135], v21 offset:4096
  v_mfma_f32_16x16x32_bf16 v[88:91], v[44:47], v[168:171], v[88:91]
  ds_read_b64_tr_b16 v[66:67], v227 offset:20480
  ds_read_b128 v[136:139], v21 offset:5120
  v_mfma_f32_16x16x32_bf16 v[92:95], v[48:51], v[164:167], v[92:95]
  s_waitcnt vmcnt(7)
  s_barrier
  ds_read_b64_tr_b16 v[36:37], v4 offset:49152
  ds_read_b128 v[140:143], v21 offset:6144
  v_mfma_f32_16x16x32_bf16 v[96:99], v[48:51], v[168:171], v[96:99]
  ds_read_b64_tr_b16 v[38:39], v4 offset:53248
  ds_read_b128 v[144:147], v21 offset:7168
  s_waitcnt vmcnt(5) lgkmcnt(13)
  v_mfma_f32_16x16x32_bf16 v[68:71], v[52:55], v[236:239], v[68:71]
  ds_read_b64_tr_b16 v[40:41], v5 offset:49152
  v_mfma_f32_16x16x32_bf16 v[72:75], v[52:55], v[240:243], v[72:75]
  ds_read_b64_tr_b16 v[42:43], v5 offset:53248
  v_mfma_f32_16x16x32_bf16 v[76:79], v[56:59], v[236:239], v[76:79]
  ds_read_b64_tr_b16 v[44:45], v6 offset:49152
  v_mfma_f32_16x16x32_bf16 v[80:83], v[56:59], v[240:243], v[80:83]
  s_nop 1
  v_add_f32 v68, v68, v180
  v_add_f32 v69, v69, v181
  ds_read_b64_tr_b16 v[46:47], v6 offset:53248
  s_waitcnt lgkmcnt(9)
  v_mfma_f32_16x16x32_bf16 v[84:87], v[60:63], v[236:239], v[84:87]
  v_add_f32 v70, v70, v182
  v_add_f32 v71, v71, v183
  ds_read_b64_tr_b16 v[48:49], v7 offset:49152
  v_mfma_f32_16x16x32_bf16 v[88:91], v[60:63], v[240:243], v[88:91]
  v_add_f32 v72, v72, v184
  v_add_f32 v73, v73, v185
  ds_read_b64_tr_b16 v[50:51], v7 offset:53248
  v_mfma_f32_16x16x32_bf16 v[92:95], v[64:67], v[236:239], v[92:95]
  v_add_f32 v74, v74, v186
  v_add_f32 v75, v75, v187
  v_mfma_f32_16x16x32_bf16 v[96:99], v[64:67], v[240:243], v[96:99]
  v_add_f32 v76, v76, v188
  v_add_f32 v77, v77, v189
  s_waitcnt vmcnt(3) lgkmcnt(4)
  v_mfma_f32_16x16x32_bf16 v[68:71], v[36:39], v[172:175], v[68:71]
  v_add_f32 v78, v78, v190
  v_add_f32 v79, v79, v191
  v_mfma_f32_16x16x32_bf16 v[72:75], v[36:39], v[176:179], v[72:75]
  v_add_f32 v80, v80, v192
  v_add_f32 v81, v81, v193
  v_mfma_f32_16x16x32_bf16 v[76:79], v[40:43], v[172:175], v[76:79]
  v_add_f32 v82, v82, v194
  v_add_f32 v83, v83, v195
  s_nop 1
  v_mfma_f32_16x16x32_bf16 v[80:83], v[40:43], v[176:179], v[80:83]
  s_waitcnt lgkmcnt(0)
  v_mfma_f32_16x16x32_bf16 v[84:87], v[44:47], v[172:175], v[84:87]
  v_mfma_f32_16x16x32_bf16 v[88:91], v[44:47], v[176:179], v[88:91]
  v_mfma_f32_16x16x32_bf16 v[92:95], v[48:51], v[172:175], v[92:95]
  v_mfma_f32_16x16x32_bf16 v[96:99], v[48:51], v[176:179], v[96:99]
  v_cvt_pk_bf16_f32 v52, v68, v69
  v_cvt_pk_bf16_f32 v53, v70, v71
  v_cvt_pk_bf16_f32 v54, v76, v77
  v_cvt_pk_bf16_f32 v55, v78, v79
  v_min_u32 v52, s73, v52
  v_min_u32 v53, s73, v53
  v_min_u32 v54, s73, v54
  v_min_u32 v55, s73, v55
  buffer_store_dwordx4 v[52:55], v27, s[28:31], s74 offen sc1
  v_cvt_pk_bf16_f32 v56, v72, v73
  v_cvt_pk_bf16_f32 v57, v74, v75
  v_cvt_pk_bf16_f32 v58, v80, v81
  v_cvt_pk_bf16_f32 v59, v82, v83
  v_min_u32 v56, s73, v56
  v_min_u32 v57, s73, v57
  v_min_u32 v58, s73, v58
  v_min_u32 v59, s73, v59
  buffer_store_dwordx4 v[56:59], v27, s[28:31], s75 offen sc1
  v_add_f32 v84, v84, v132
  v_add_f32 v85, v85, v133
  v_add_f32 v86, v86, v134
  v_add_f32 v87, v87, v135
  v_cvt_pk_bf16_f32 v60, v84, v85
  v_cvt_pk_bf16_f32 v61, v86, v87
  v_add_f32 v92, v92, v140
  v_add_f32 v93, v93, v141
  v_add_f32 v94, v94, v142
  v_add_f32 v95, v95, v143
  v_cvt_pk_bf16_f32 v62, v92, v93
  v_cvt_pk_bf16_f32 v63, v94, v95
  v_min_u32 v60, s73, v60
  v_min_u32 v61, s73, v61
  v_min_u32 v62, s73, v62
  v_min_u32 v63, s73, v63
  buffer_store_dwordx4 v[60:63], v27, s[28:31], s76 offen sc1
  v_add_f32 v88, v88, v136
  v_add_f32 v89, v89, v137
  v_add_f32 v90, v90, v138
  v_add_f32 v91, v91, v139
  v_cvt_pk_bf16_f32 v64, v88, v89
  v_cvt_pk_bf16_f32 v65, v90, v91
  v_add_f32 v96, v96, v144
  v_add_f32 v97, v97, v145
  v_add_f32 v98, v98, v146
  v_add_f32 v99, v99, v147
  v_cvt_pk_bf16_f32 v66, v96, v97
  v_cvt_pk_bf16_f32 v67, v98, v99
  v_min_u32 v64, s73, v64
  v_min_u32 v65, s73, v65
  v_min_u32 v66, s73, v66
  v_min_u32 v67, s73, v67
  buffer_store_dwordx4 v[64:67], v27, s[28:31], s77 offen sc1
  s_waitcnt vmcnt(4)
  v_permlane16_swap_b32 v196, v198
  v_permlane16_swap_b32 v197, v199
  s_nop 0
  v_permlane32_swap_b32 v196, v198
  v_permlane32_swap_b32 v197, v199
  v_lshlrev_b32 v212, 16, v200
  v_and_b32 v213, 0xffff0000, v200
  v_lshlrev_b32 v214, 16, v201
  v_and_b32 v215, 0xffff0000, v201
  v_lshlrev_b32 v216, 16, v202
  v_and_b32 v217, 0xffff0000, v202
  v_lshlrev_b32 v218, 16, v203
  v_and_b32 v219, 0xffff0000, v203
  v_lshlrev_b32 v204, 16, v196
  v_and_b32 v205, 0xffff0000, v196
  v_lshlrev_b32 v206, 16, v197
  v_and_b32 v207, 0xffff0000, v197
  v_lshlrev_b32 v208, 16, v198
  v_and_b32 v209, 0xffff0000, v198
  v_lshlrev_b32 v210, 16, v199
  v_and_b32 v211, 0xffff0000, v199
  s_waitcnt vmcnt(0) lgkmcnt(0)
L_poll:
  buffer_load_dwordx4 v[36:39], v27, s[28:31], s78 offen sc1
  buffer_load_dwordx4 v[40:43], v27, s[28:31], s79 offen sc1
  buffer_load_dwordx4 v[44:47], v27, s[28:31], s80 offen sc1
  buffer_load_dwordx4 v[48:51], v27, s[28:31], s81 offen sc1
L_poll1:
  s_add_u32 s72, s72, 1
  s_waitcnt vmcnt(0) lgkmcnt(0)
  v_max3_u32 v28, v36, v37, v38
  v_max3_u32 v29, v39, v40, v41
  v_max3_u32 v28, v28, v42, v43
  v_max3_u32 v29, v29, v44, v45
  v_max3_u32 v28, v28, v46, v47
  v_max3_u32 v29, v29, v48, v49
  v_max3_u32 v28, v28, v50, v51
  v_max_u32 v28, v28, v29
  v_cmp_eq_u32 vcc, -1, v28
  s_cbranch_vccz L_go
  s_bitcmp1_b32 s72, 14
  s_cbranch_scc1 L_go
  s_sleep 2
  s_branch L_poll
L_go:
  s_cmp_lg_u32 s85, 0
  s_cbranch_scc1 L_own0
  v_mov_b32 v36, v52
  v_mov_b32 v37, v53
  v_mov_b32 v38, v54
  v_mov_b32 v39, v55
L_own0:
  s_cmp_lg_u32 s85, 1
  s_cbranch_scc1 L_own1
  v_mov_b32 v40, v56
  v_mov_b32 v41, v57
  v_mov_b32 v42, v58
  v_mov_b32 v43, v59
L_own1:
  s_cmp_lg_u32 s85, 2
  s_cbranch_scc1 L_own2
  v_mov_b32 v44, v60
  v_mov_b32 v45, v61
  v_mov_b32 v46, v62
  v_mov_b32 v47, v63
L_own2:
  s_cmp_lg_u32 s85, 3
  s_cbranch_scc1 L_own3
  v_mov_b32 v48, v64
  v_mov_b32 v49, v65
  v_mov_b32 v50, v66
  v_mov_b32 v51, v67
L_own3:
  v_lshlrev_b32 v70, 16, v48
  v_and_b32 v74, 0xffff0000, v48
  v_lshlrev_b32 v78, 16, v49
  v_and_b32 v82, 0xffff0000, v49
  v_lshlrev_b32 v86, 16, v50
  v_and_b32 v90, 0xffff0000, v50
  v_lshlrev_b32 v94, 16, v51
  v_and_b32 v98, 0xffff0000, v51
  v_add_f32 v70, v70, v212
  v_add_f32 v74, v74, v213
  v_add_f32 v78, v78, v214
  v_add_f32 v82, v82, v215
  v_add_f32 v86, v86, v216
  v_add_f32 v90, v90, v217
  v_add_f32 v94, v94, v218
  v_add_f32 v98, v98, v219
  v_mul_f32 v69, 0xbfb8aa3b, v70
  v_mul_f32 v73, 0xbfb8aa3b, v74
  v_mul_f32 v77, 0xbfb8aa3b, v78
  v_mul_f32 v81, 0xbfb8aa3b, v82
  v_mul_f32 v85, 0xbfb8aa3b, v86
  v_mul_f32 v89, 0xbfb8aa3b, v90
  v_mul_f32 v93, 0xbfb8aa3b, v94
  v_mul_f32 v97, 0xbfb8aa3b, v98
  v_exp_f32 v69, v69
  v_exp_f32 v73, v73
  v_exp_f32 v77, v77
  v_exp_f32 v81, v81
  v_exp_f32 v85, v85
  v_exp_f32 v89, v89
  v_exp_f32 v93, v93
  v_exp_f32 v97, v97
  v_lshlrev_b32 v68, 16, v36
  v_and_b32 v72, 0xffff0000, v36
  v_lshlrev_b32 v76, 16, v37
  v_and_b32 v80, 0xffff0000, v37
  v_lshlrev_b32 v84, 16, v38
  v_and_b32 v88, 0xffff0000, v38
  v_lshlrev_b32 v92, 16, v39
  v_and_b32 v96, 0xffff0000, v39
  v_lshlrev_b32 v71, 16, v40
  v_and_b32 v75, 0xffff0000, v40
  v_lshlrev_b32 v79, 16, v41
  v_and_b32 v83, 0xffff0000, v41
  v_lshlrev_b32 v87, 16, v42
  v_and_b32 v91, 0xffff0000, v42
  v_lshlrev_b32 v95, 16, v43
  v_and_b32 v99, 0xffff0000, v43
  v_add_f32 v69, 1.0, v69
  v_add_f32 v73, 1.0, v73
  v_add_f32 v77, 1.0, v77
  v_add_f32 v81, 1.0, v81
  v_add_f32 v85, 1.0, v85
  v_add_f32 v89, 1.0, v89
  v_add_f32 v93, 1.0, v93
  v_add_f32 v97, 1.0, v97
  v_rcp_f32 v69, v69
  v_rcp_f32 v73, v73
  v_rcp_f32 v77, v77
  v_rcp_f32 v81, v81
  v_rcp_f32 v85, v85
  v_rcp_f32 v89, v89
  v_rcp_f32 v93, v93
  v_rcp_f32 v97, v97
  v_add_f32 v68, v68, v71
  v_add_f32 v72, v72, v75
  v_add_f32 v76, v76, v79
  v_add_f32 v80, v80, v83
  v_add_f32 v84, v84, v87
  v_add_f32 v88, v88, v91
  v_add_f32 v92, v92, v95
  v_add_f32 v96, v96, v99
  v_lshlrev_b32 v71, 16, v44
  v_and_b32 v75, 0xffff0000, v44
  v_lshlrev_b32 v79, 16, v45
  v_and_b32 v83, 0xffff0000, v45
  v_lshlrev_b32 v87, 16, v46
  v_and_b32 v91, 0xffff0000, v46
  v_lshlrev_b32 v95, 16, v47
  v_and_b32 v99, 0xffff0000, v47
  v_add_f32 v68, v68, v71
  v_add_f32 v72, v72, v75
  v_add_f32 v76, v76, v79
  v_add_f32 v80, v80, v83
  v_add_f32 v84, v84, v87
  v_add_f32 v88, v88, v91
  v_add_f32 v92, v92, v95
  v_add_f32 v96, v96, v99
  v_mul_f32 v70, v70, v69
  v_mul_f32 v74, v74, v73
  v_mul_f32 v78, v78, v77
  v_mul_f32 v82, v82, v81
  v_mul_f32 v86, v86, v85
  v_mul_f32 v90, v90, v89
  v_mul_f32 v94, v94, v93
  v_mul_f32 v98, v98, v97
  v_fma_f32 v68, v68, v70, v204
  v_fma_f32 v72, v72, v74, v205
  v_fma_f32 v76, v76, v78, v206
  v_fma_f32 v80, v80, v82, v207
  v_fma_f32 v84, v84, v86, v208
  v_fma_f32 v88, v88, v90, v209
  v_fma_f32 v92, v92, v94, v210
  v_fma_f32 v96, v96, v98, v211
  v_cvt_pk_bf16_f32 v196, v68, v72
  v_cvt_pk_bf16_f32 v197, v76, v80
  v_cvt_pk_bf16_f32 v198, v84, v88
  v_cvt_pk_bf16_f32 v199, v92, v96
  s_nop 0
  v_permlane32_swap_b32 v196, v198
  v_permlane32_swap_b32 v197, v199
  s_nop 0
  v_permlane16_swap_b32 v196, v198
  v_permlane16_swap_b32 v197, v199
  buffer_store_dwordx4 v[196:199], v3, s[20:23], s68 offen
L_end:
  s_endpgm
L_slow:
  s_waitcnt vmcnt(0) lgkmcnt(0)
  s_nop 15
  v_lshlrev_b32 v33, 8, v25
  v_lshl_add_u32 v33, v24, 4, v33
  v_add_u32 v28, 4096, v33
  v_lshlrev_b32 v34, 10, v24
  v_lshl_add_u32 v34, v25, 1, v34
  v_add_u32 v35, 4096, v34
  v_mov_b32 v148, 0xff800000
  v_mov_b32 v150, 0xff800000
  s_mov_b32 s62, s46
  s_mov_b32 s60, 16
L_s1:
  buffer_load_dwordx4 v[36:39], v33, s[20:23], s62 offen offset:0
  buffer_load_dwordx4 v[40:43], v33, s[20:23], s62 offen offset:64
  buffer_load_dwordx4 v[44:47], v33, s[20:23], s62 offen offset:128
  buffer_load_dwordx4 v[48:51], v33, s[20:23], s62 offen offset:192
  buffer_load_dwordx4 v[52:55], v28, s[20:23], s62 offen offset:0
  buffer_load_dwordx4 v[56:59], v28, s[20:23], s62 offen offset:64
  buffer_load_dwordx4 v[60:63], v28, s[20:23], s62 offen offset:128
  buffer_load_dwordx4 v[64:67], v28, s[20:23], s62 offen offset:192
  s_waitcnt vmcnt(0)
  v_mfma_f32_16x16x32_bf16 v[188:191], v[36:39], v[156:159], 0
  v_mfma_f32_16x16x32_bf16 v[196:199], v[36:39], v[172:175], 0
  v_mfma_f32_16x16x32_bf16 v[188:191], v[40:43], v[160:163], v[188:191]
  v_mfma_f32_16x16x32_bf16 v[196:199], v[40:43], v[176:179], v[196:199]
  v_mfma_f32_16x16x32_bf16 v[188:191], v[44:47], v[164:167], v[188:191]
  v_mfma_f32_16x16x32_bf16 v[196:199], v[44:47], v[180:183], v[196:199]
  v_mfma_f32_16x16x32_bf16 v[188:191], v[48:51], v[168:171], v[188:191]
  v_mfma_f32_16x16x32_bf16 v[196:199], v[48:51], v[184:187], v[196:199]
  v_mfma_f32_16x16x32_bf16 v[192:195], v[52:55], v[156:159], 0
  v_mfma_f32_16x16x32_bf16 v[200:203], v[52:55], v[172:175], 0
  v_mfma_f32_16x16x32_bf16 v[192:195], v[56:59], v[160:163], v[192:195]
  v_mfma_f32_16x16x32_bf16 v[200:203], v[56:59], v[176:179], v[200:203]
  v_mfma_f32_16x16x32_bf16 v[192:195], v[60:63], v[164:167], v[192:195]
  v_mfma_f32_16x16x32_bf16 v[200:203], v[60:63], v[180:183], v[200:203]
  v_mfma_f32_16x16x32_bf16 v[192:195], v[64:67], v[168:171], v[192:195]
  v_mfma_f32_16x16x32_bf16 v[200:203], v[64:67], v[184:187], v[200:203]
  s_nop 7
  v_max3_f32 v148, v148, v188, v189
  v_max3_f32 v148, v148, v190, v191
  v_max3_f32 v148, v148, v192, v193
  v_max3_f32 v148, v148, v194, v195
  v_max3_f32 v150, v150, v196, v197
  v_max3_f32 v150, v150, v198, v199
  v_max3_f32 v150, v150, v200, v201
  v_max3_f32 v150, v150, v202, v203
  s_add_u32 s62, s62, 8192
  s_sub_u32 s60, s60, 1
  s_cmp_lg_u32 s60, 0
  s_cbranch_scc1 L_s1
  v_mov_b32 v149, v148
  s_nop 1
  v_permlane16_swap_b32 v148, v149
  v_max_f32 v148, v148, v149
  v_mov_b32 v151, v150
  s_nop 1
  v_permlane16_swap_b32 v150, v151
  v_max_f32 v150, v150, v151
  v_mov_b32 v149, v148
  s_nop 1
  v_permlane32_swap_b32 v148, v149
  v_max_f32 v148, v148, v149
  v_mov_b32 v151, v150
  s_nop 1
  v_permlane32_swap_b32 v150, v151
  v_max_f32 v150, v150, v151
  v_sub_f32 v220, 0, v148
  v_sub_f32 v221, 0, v148
  v_sub_f32 v222, 0, v148
  v_sub_f32 v223, 0, v148
  v_sub_f32 v224, 0, v150
  v_sub_f32 v225, 0, v150
  v_sub_f32 v226, 0, v150
  v_sub_f32 v227, 0, v150
  v_mov_b32 v68, 0
  v_mov_b32 v69, 0
  v_mov_b32 v70, 0
  v_mov_b32 v71, 0
  v_mov_b32 v72, 0
  v_mov_b32 v73, 0
  v_mov_b32 v74, 0
  v_mov_b32 v75, 0
  v_mov_b32 v76, 0
  v_mov_b32 v77, 0
  v_mov_b32 v78, 0
  v_mov_b32 v79, 0
  v_mov_b32 v80, 0
  v_mov_b32 v81, 0
  v_mov_b32 v82, 0
  v_mov_b32 v83, 0
  v_mov_b32 v84, 0
  v_mov_b32 v85, 0
  v_mov_b32 v86, 0
  v_mov_b32 v87, 0
  v_mov_b32 v88, 0
  v_mov_b32 v89, 0
  v_mov_b32 v90, 0
  v_mov_b32 v91, 0
  v_mov_b32 v92, 0
  v_mov_b32 v93, 0
  v_mov_b32 v94, 0
  v_mov_b32 v95, 0
  v_mov_b32 v96, 0
  v_mov_b32 v97, 0
  v_mov_b32 v98, 0
  v_mov_b32 v99, 0
  v_mov_b32 v100, 0
  v_mov_b32 v101, 0
  v_mov_b32 v102, 0
  v_mov_b32 v103, 0
  v_mov_b32 v104, 0
  v_mov_b32 v105, 0
  v_mov_b32 v106, 0
  v_mov_b32 v107, 0
  v_mov_b32 v108, 0
  v_mov_b32 v109, 0
  v_mov_b32 v110, 0
  v_mov_b32 v111, 0
  v_mov_b32 v112, 0
  v_mov_b32 v113, 0
  v_mov_b32 v114, 0
  v_mov_b32 v115, 0
  v_mov_b32 v116, 0
  v_mov_b32 v117, 0
  v_mov_b32 v118, 0
  v_mov_b32 v119, 0
  v_mov_b32 v120, 0
  v_mov_b32 v121, 0
  v_mov_b32 v122, 0
  v_mov_b32 v123, 0
  v_mov_b32 v124, 0
  v_mov_b32 v125, 0
  v_mov_b32 v126, 0
  v_mov_b32 v127, 0
  v_mov_b32 v128, 0
  v_mov_b32 v129, 0
  v_mov_b32 v130, 0
  v_mov_b32 v131, 0
  v_mov_b32 v148, 0
  v_mov_b32 v150, 0
  s_mov_b32 s62, s46
  s_mov_b32 s60, 16
L_s2:
  buffer_load_dwordx4 v[36:39], v33, s[20:23], s62 offen offset:0
  buffer_load_dwordx4 v[40:43], v33, s[20:23], s62 offen offset:64
  buffer_load_dwordx4 v[44:47], v33, s[20:23], s62 offen offset:128
  buffer_load_dwordx4 v[48:51], v33, s[20:23], s62 offen offset:192
  buffer_load_dwordx4 v[52:55], v28, s[20:23], s62 offen offset:0
  buffer_load_dwordx4 v[56:59], v28, s[20:23], s62 offen offset:64
  buffer_load_dwordx4 v[60:63], v28, s[20:23], s62 offen offset:128
  buffer_load_dwordx4 v[64:67], v28, s[20:23], s62 offen offset:192
  s_waitcnt vmcnt(0)
  v_mfma_f32_16x16x32_bf16 v[188:191], v[36:39], v[156:159], v[220:223]
  v_mfma_f32_16x16x32_bf16 v[196:199], v[36:39], v[172:175], v[224:227]
  v_mfma_f32_16x16x32_bf16 v[188:191], v[40:43], v[160:163], v[188:191]
  v_mfma_f32_16x16x32_bf16 v[196:199], v[40:43], v[176:179], v[196:199]
  v_mfma_f32_16x16x32_bf16 v[188:191], v[44:47], v[164:167], v[188:191]
  v_mfma_f32_16x16x32_bf16 v[196:199], v[44:47], v[180:183], v[196:199]
  v_mfma_f32_16x16x32_bf16 v[188:191], v[48:51], v[168:171], v[188:191]
  v_mfma_f32_16x16x32_bf16 v[196:199], v[48:51], v[184:187], v[196:199]
  v_mfma_f32_16x16x32_bf16 v[192:195], v[52:55], v[156:159], v[220:223]
  v_mfma_f32_16x16x32_bf16 v[200:203], v[52:55], v[172:175], v[224:227]
  v_mfma_f32_16x16x32_bf16 v[192:195], v[56:59], v[160:163], v[192:195]
  v_mfma_f32_16x16x32_bf16 v[200:203], v[56:59], v[176:179], v[200:203]
  v_mfma_f32_16x16x32_bf16 v[192:195], v[60:63], v[164:167], v[192:195]
  v_mfma_f32_16x16x32_bf16 v[200:203], v[60:63], v[180:183], v[200:203]
  v_mfma_f32_16x16x32_bf16 v[192:195], v[64:67], v[168:171], v[192:195]
  v_mfma_f32_16x16x32_bf16 v[200:203], v[64:67], v[184:187], v[200:203]
  s_nop 7
  v_exp_f32 v188, v188
  v_exp_f32 v189, v189
  v_exp_f32 v190, v190
  v_exp_f32 v191, v191
  v_exp_f32 v192, v192
  v_exp_f32 v193, v193
  v_exp_f32 v194, v194
  v_exp_f32 v195, v195
  v_exp_f32 v196, v196
  v_exp_f32 v197, v197
  v_exp_f32 v198, v198
  v_exp_f32 v199, v199
  v_exp_f32 v200, v200
  v_exp_f32 v201, v201
  v_exp_f32 v202, v202
  v_exp_f32 v203, v203
  v_add_f32 v148, v148, v188
  v_add_f32 v148, v148, v189
  v_add_f32 v148, v148, v190
  v_add_f32 v148, v148, v191
  v_add_f32 v148, v148, v192
  v_add_f32 v148, v148, v193
  v_add_f32 v148, v148, v194
  v_add_f32 v148, v148, v195
  v_add_f32 v150, v150, v196
  v_add_f32 v150, v150, v197
  v_add_f32 v150, v150, v198
  v_add_f32 v150, v150, v199
  v_add_f32 v150, v150, v200
  v_add_f32 v150, v150, v201
  v_add_f32 v150, v150, v202
  v_add_f32 v150, v150, v203
  v_cvt_pk_bf16_f32 v132, v188, v189
  v_cvt_pk_bf16_f32 v133, v190, v191
  v_cvt_pk_bf16_f32 v134, v192, v193
  v_cvt_pk_bf16_f32 v135, v194, v195
  v_cvt_pk_bf16_f32 v136, v196, v197
  v_cvt_pk_bf16_f32 v137, v198, v199
  v_cvt_pk_bf16_f32 v138, v200, v201
  v_cvt_pk_bf16_f32 v139, v202, v203
  buffer_load_ushort v204, v34, s[24:27], s62 offen offset:0
  buffer_load_ushort v205, v34, s[24:27], s62 offen offset:256
  buffer_load_ushort v206, v34, s[24:27], s62 offen offset:512
  buffer_load_ushort v207, v34, s[24:27], s62 offen offset:768
  buffer_load_ushort v208, v35, s[24:27], s62 offen offset:0
  buffer_load_ushort v209, v35, s[24:27], s62 offen offset:256
  buffer_load_ushort v210, v35, s[24:27], s62 offen offset:512
  buffer_load_ushort v211, v35, s[24:27], s62 offen offset:768
  buffer_load_ushort v212, v34, s[24:27], s62 offen offset:32
  buffer_load_ushort v213, v34, s[24:27], s62 offen offset:288
  buffer_load_ushort v214, v34, s[24:27], s62 offen offset:544
  buffer_load_ushort v215, v34, s[24:27], s62 offen offset:800
  buffer_load_ushort v216, v35, s[24:27], s62 offen offset:32
  buffer_load_ushort v217, v35, s[24:27], s62 offen offset:288
  buffer_load_ushort v218, v35, s[24:27], s62 offen offset:544
  buffer_load_ushort v219, v35, s[24:27], s62 offen offset:800
  s_waitcnt vmcnt(0)
  v_lshl_or_b32 v36, v205, 16, v204
  v_lshl_or_b32 v37, v207, 16, v206
  v_lshl_or_b32 v38, v209, 16, v208
  v_lshl_or_b32 v39, v211, 16, v210
  v_lshl_or_b32 v40, v213, 16, v212
  v_lshl_or_b32 v41, v215, 16, v214
  v_lshl_or_b32 v42, v217, 16, v216
  v_lshl_or_b32 v43, v219, 16, v218
  buffer_load_ushort v204, v34, s[24:27], s62 offen offset:64
  buffer_load_ushort v205, v34, s[24:27], s62 offen offset:320
  buffer_load_ushort v206, v34, s[24:27], s62 offen offset:576
  buffer_load_ushort v207, v34, s[24:27], s62 offen offset:832
  buffer_load_ushort v208, v35, s[24:27], s62 offen offset:64
  buffer_load_ushort v209, v35, s[24:27], s62 offen offset:320
  buffer_load_ushort v210, v35, s[24:27], s62 offen offset:576
  buffer_load_ushort v211, v35, s[24:27], s62 offen offset:832
  buffer_load_ushort v212, v34, s[24:27], s62 offen offset:96
  buffer_load_ushort v213, v34, s[24:27], s62 offen offset:352
  buffer_load_ushort v214, v34, s[24:27], s62 offen offset:608
  buffer_load_ushort v215, v34, s[24:27], s62 offen offset:864
  buffer_load_ushort v216, v35, s[24:27], s62 offen offset:96
  buffer_load_ushort v217, v35, s[24:27], s62 offen offset:352
  buffer_load_ushort v218, v35, s[24:27], s62 offen offset:608
  buffer_load_ushort v219, v35, s[24:27], s62 offen offset:864
  s_waitcnt vmcnt(0)
  v_lshl_or_b32 v44, v205, 16, v204
  v_lshl_or_b32 v45, v207, 16, v206
  v_lshl_or_b32 v46, v209, 16, v208
  v_lshl_or_b32 v47, v211, 16, v210
  v_lshl_or_b32 v48, v213, 16, v212
  v_lshl_or_b32 v49, v215, 16, v214
  v_lshl_or_b32 v50, v217, 16, v216
  v_lshl_or_b32 v51, v219, 16, v218
  buffer_load_ushort v204, v34, s[24:27], s62 offen offset:128
  buffer_load_ushort v205, v34, s[24:27], s62 offen offset:384
  buffer_load_ushort v206, v34, s[24:27], s62 offen offset:640
  buffer_load_ushort v207, v34, s[24:27], s62 offen offset:896
  buffer_load_ushort v208, v35, s[24:27], s62 offen offset:128
  buffer_load_ushort v209, v35, s[24:27], s62 offen offset:384
  buffer_load_ushort v210, v35, s[24:27], s62 offen offset:640
  buffer_load_ushort v211, v35, s[24:27], s62 offen offset:896
  buffer_load_ushort v212, v34, s[24:27], s62 offen offset:160
  buffer_load_ushort v213, v34, s[24:27], s62 offen offset:416
  buffer_load_ushort v214, v34, s[24:27], s62 offen offset:672
  buffer_load_ushort v215, v34, s[24:27], s62 offen offset:928
  buffer_load_ushort v216, v35, s[24:27], s62 offen offset:160
  buffer_load_ushort v217, v35, s[24:27], s62 offen offset:416
  buffer_load_ushort v218, v35, s[24:27], s62 offen offset:672
  buffer_load_ushort v219, v35, s[24:27], s62 offen offset:928
  s_waitcnt vmcnt(0)
  v_lshl_or_b32 v52, v205, 16, v204
  v_lshl_or_b32 v53, v207, 16, v206
  v_lshl_or_b32 v54, v209, 16, v208
  v_lshl_or_b32 v55, v211, 16, v210
  v_lshl_or_b32 v56, v213, 16, v212
  v_lshl_or_b32 v57, v215, 16, v214
  v_lshl_or_b32 v58, v217, 16, v216
  v_lshl_or_b32 v59, v219, 16, v218
  buffer_load_ushort v204, v34, s[24:27], s62 offen offset:192
  buffer_load_ushort v205, v34, s[24:27], s62 offen offset:448
  buffer_load_ushort v206, v34, s[24:27], s62 offen offset:704
  buffer_load_ushort v207, v34, s[24:27], s62 offen offset:960
  buffer_load_ushort v208, v35, s[24:27], s62 offen offset:192
  buffer_load_ushort v209, v35, s[24:27], s62 offen offset:448
  buffer_load_ushort v210, v35, s[24:27], s62 offen offset:704
  buffer_load_ushort v211, v35, s[24:27], s62 offen offset:960
  buffer_load_ushort v212, v34, s[24:27], s62 offen offset:224
  buffer_load_ushort v213, v34, s[24:27], s62 offen offset:480
  buffer_load_ushort v214, v34, s[24:27], s62 offen offset:736
  buffer_load_ushort v215, v34, s[24:27], s62 offen offset:992
  buffer_load_ushort v216, v35, s[24:27], s62 offen offset:224
  buffer_load_ushort v217, v35, s[24:27], s62 offen offset:480
  buffer_load_ushort v218, v35, s[24:27], s62 offen offset:736
  buffer_load_ushort v219, v35, s[24:27], s62 offen offset:992
  s_waitcnt vmcnt(0)
  v_lshl_or_b32 v60, v205, 16, v204
  v_lshl_or_b32 v61, v207, 16, v206
  v_lshl_or_b32 v62, v209, 16, v208
  v_lshl_or_b32 v63, v211, 16, v210
  v_lshl_or_b32 v64, v213, 16, v212
  v_lshl_or_b32 v65, v215, 16, v214
  v_lshl_or_b32 v66, v217, 16, v216
  v_lshl_or_b32 v67, v219, 16, v218
  v_mfma_f32_16x16x32_bf16 v[68:71], v[36:39], v[132:135], v[68:71]
  v_mfma_f32_16x16x32_bf16 v[72:75], v[36:39], v[136:139], v[72:75]
  v_mfma_f32_16x16x32_bf16 v[76:79], v[40:43], v[132:135], v[76:79]
  v_mfma_f32_16x16x32_bf16 v[80:83], v[40:43], v[136:139], v[80:83]
  v_mfma_f32_16x16x32_bf16 v[84:87], v[44:47], v[132:135], v[84:87]
  v_mfma_f32_16x16x32_bf16 v[88:91], v[44:47], v[136:139], v[88:91]
  v_mfma_f32_16x16x32_bf16 v[92:95], v[48:51], v[132:135], v[92:95]
  v_mfma_f32_16x16x32_bf16 v[96:99], v[48:51], v[136:139], v[96:99]
  v_mfma_f32_16x16x32_bf16 v[100:103], v[52:55], v[132:135], v[100:103]
  v_mfma_f32_16x16x32_bf16 v[104:107], v[52:55], v[136:139], v[104:107]
  v_mfma_f32_16x16x32_bf16 v[108:111], v[56:59], v[132:135], v[108:111]
  v_mfma_f32_16x16x32_bf16 v[112:115], v[56:59], v[136:139], v[112:115]
  v_mfma_f32_16x16x32_bf16 v[116:119], v[60:63], v[132:135], v[116:119]
  v_mfma_f32_16x16x32_bf16 v[120:123], v[60:63], v[136:139], v[120:123]
  v_mfma_f32_16x16x32_bf16 v[124:127], v[64:67], v[132:135], v[124:127]
  v_mfma_f32_16x16x32_bf16 v[128:131], v[64:67], v[136:139], v[128:131]
  s_add_u32 s62, s62, 8192
  s_sub_u32 s60, s60, 1
  s_cmp_lg_u32 s60, 0
  s_nop 7
  s_cbranch_scc1 L_s2
  v_mov_b32 v149, v148
  s_nop 1
  v_permlane16_swap_b32 v148, v149
  v_add_f32 v148, v148, v149
  v_mov_b32 v151, v150
  s_nop 1
  v_permlane16_swap_b32 v150, v151
  v_add_f32 v150, v150, v151
  v_mov_b32 v149, v148
  s_nop 1
  v_permlane32_swap_b32 v148, v149
  v_add_f32 v148, v148, v149
  v_mov_b32 v151, v150
  s_nop 1
  v_permlane32_swap_b32 v150, v151
  v_add_f32 v150, v150, v151
  v_rcp_f32 v28, v148
  v_rcp_f32 v29, v150
  v_mul_f32 v68, v28, v68
  v_mul_f32 v69, v28, v69
  v_mul_f32 v70, v28, v70
  v_mul_f32 v71, v28, v71
  v_cvt_pk_bf16_f32 v156, v68, v69
  v_cvt_pk_bf16_f32 v157, v70, v71
  v_mul_f32 v76, v28, v76
  v_mul_f32 v77, v28, v77
  v_mul_f32 v78, v28, v78
  v_mul_f32 v79, v28, v79
  v_cvt_pk_bf16_f32 v158, v76, v77
  v_cvt_pk_bf16_f32 v159, v78, v79
  buffer_store_dwordx4 v[156:159], v27, s[28:31], s52 offen offset:0 sc1
  v_mul_f32 v72, v29, v72
  v_mul_f32 v73, v29, v73
  v_mul_f32 v74, v29, v74
  v_mul_f32 v75, v29, v75
  v_cvt_pk_bf16_f32 v172, v72, v73
  v_cvt_pk_bf16_f32 v173, v74, v75
  v_mul_f32 v80, v29, v80
  v_mul_f32 v81, v29, v81
  v_mul_f32 v82, v29, v82
  v_mul_f32 v83, v29, v83
  v_cvt_pk_bf16_f32 v174, v80, v81
  v_cvt_pk_bf16_f32 v175, v82, v83
  buffer_store_dwordx4 v[172:175], v27, s[28:31], s53 offen offset:0 sc1
  v_mul_f32 v84, v28, v84
  v_mul_f32 v85, v28, v85
  v_mul_f32 v86, v28, v86
  v_mul_f32 v87, v28, v87
  v_cvt_pk_bf16_f32 v160, v84, v85
  v_cvt_pk_bf16_f32 v161, v86, v87
  v_mul_f32 v92, v28, v92
  v_mul_f32 v93, v28, v93
  v_mul_f32 v94, v28, v94
  v_mul_f32 v95, v28, v95
  v_cvt_pk_bf16_f32 v162, v92, v93
  v_cvt_pk_bf16_f32 v163, v94, v95
  buffer_store_dwordx4 v[160:163], v27, s[28:31], s52 offen offset:1024 sc1
  v_mul_f32 v88, v29, v88
  v_mul_f32 v89, v29, v89
  v_mul_f32 v90, v29, v90
  v_mul_f32 v91, v29, v91
  v_cvt_pk_bf16_f32 v176, v88, v89
  v_cvt_pk_bf16_f32 v177, v90, v91
  v_mul_f32 v96, v29, v96
  v_mul_f32 v97, v29, v97
  v_mul_f32 v98, v29, v98
  v_mul_f32 v99, v29, v99
  v_cvt_pk_bf16_f32 v178, v96, v97
  v_cvt_pk_bf16_f32 v179, v98, v99
  buffer_store_dwordx4 v[176:179], v27, s[28:31], s53 offen offset:1024 sc1
  v_mul_f32 v100, v28, v100
  v_mul_f32 v101, v28, v101
  v_mul_f32 v102, v28, v102
  v_mul_f32 v103, v28, v103
  v_cvt_pk_bf16_f32 v164, v100, v101
  v_cvt_pk_bf16_f32 v165, v102, v103
  v_mul_f32 v108, v28, v108
  v_mul_f32 v109, v28, v109
  v_mul_f32 v110, v28, v110
  v_mul_f32 v111, v28, v111
  v_cvt_pk_bf16_f32 v166, v108, v109
  v_cvt_pk_bf16_f32 v167, v110, v111
  buffer_store_dwordx4 v[164:167], v27, s[28:31], s52 offen offset:2048 sc1
  v_mul_f32 v104, v29, v104
  v_mul_f32 v105, v29, v105
  v_mul_f32 v106, v29, v106
  v_mul_f32 v107, v29, v107
  v_cvt_pk_bf16_f32 v180, v104, v105
  v_cvt_pk_bf16_f32 v181, v106, v107
  v_mul_f32 v112, v29, v112
  v_mul_f32 v113, v29, v113
  v_mul_f32 v114, v29, v114
  v_mul_f32 v115, v29, v115
  v_cvt_pk_bf16_f32 v182, v112, v113
  v_cvt_pk_bf16_f32 v183, v114, v115
  buffer_store_dwordx4 v[180:183], v27, s[28:31], s53 offen offset:2048 sc1
  v_mul_f32 v116, v28, v116
  v_mul_f32 v117, v28, v117
  v_mul_f32 v118, v28, v118
  v_mul_f32 v119, v28, v119
  v_cvt_pk_bf16_f32 v168, v116, v117
  v_cvt_pk_bf16_f32 v169, v118, v119
  v_mul_f32 v124, v28, v124
  v_mul_f32 v125, v28, v125
  v_mul_f32 v126, v28, v126
  v_mul_f32 v127, v28, v127
  v_cvt_pk_bf16_f32 v170, v124, v125
  v_cvt_pk_bf16_f32 v171, v126, v127
  buffer_store_dwordx4 v[168:171], v27, s[28:31], s52 offen offset:3072 sc1
  v_mul_f32 v120, v29, v120
  v_mul_f32 v121, v29, v121
  v_mul_f32 v122, v29, v122
  v_mul_f32 v123, v29, v123
  v_cvt_pk_bf16_f32 v184, v120, v121
  v_cvt_pk_bf16_f32 v185, v122, v123
  v_mul_f32 v128, v29, v128
  v_mul_f32 v129, v29, v129
  v_mul_f32 v130, v29, v130
  v_mul_f32 v131, v29, v131
  v_cvt_pk_bf16_f32 v186, v128, v129
  v_cvt_pk_bf16_f32 v187, v130, v131
  buffer_store_dwordx4 v[184:187], v27, s[28:31], s53 offen offset:3072 sc1
  s_nop 3
  s_branch L_join
.section .rodata,"a"
.p2align 6
.amdhsa_kernel recurrent_scan__sliding_block_cached__dense_activation_squared_relu__prompt_kernel
  .amdhsa_next_free_vgpr 256
  .amdhsa_next_free_sgpr 102
  .amdhsa_accum_offset 256
  .amdhsa_group_segment_fixed_size 0
  .amdhsa_kernarg_size 104
  .amdhsa_user_sgpr_count 2
  .amdhsa_user_sgpr_kernarg_segment_ptr 1
  .amdhsa_system_sgpr_workgroup_id_x 1
.end_amdhsa_kernel
```
